```python
import torch

def _softmax(x, axis=-1):
    return torch.softmax(x, dim=axis)

def _gelu(x):
    return torch.nn.functional.gelu(x, approximate='tanh')

def _silu(x):
    return torch.nn.functional.silu(x)

def _sigmoid(x):
    return torch.sigmoid(x)

def _layernorm(x, axis=-1, eps=1e-05):
    m = x.mean(dim=axis, keepdim=True)
    v = x.var(dim=axis, keepdim=True, unbiased=False)
    return (x - m) / torch.sqrt(v + eps)

def _scatter_add(tgt, idx, src, axis=0):
    return tgt.clone().index_add_(axis, idx, src)

def _segment_sum(src, seg, n):
    out = torch.zeros((n,) + src.shape[1:], dtype=src.dtype)
    return out.index_add_(0, seg, src)

def _pad(x, pw):
    flat = tuple((v for pair in reversed(pw) for v in pair))
    return torch.nn.functional.pad(x, flat)
kernel_name = 'adaLN_cond__mha_block_cached__dense_activation_silu__decode'

def setup_inputs():

    _w = lambda a: (lambda t: t.to(torch.bfloat16) if t.is_floating_point() else t)(torch.as_tensor(a))

    def _A_setup():
        B, Sq, D = (2, 1, 448)
        H, Sk, Dh = (16, 32768, 256)
        return {'x': _w((lambda *s: torch.randn(*s, dtype=torch.bfloat16) * 0.1)(B, Sq, D)), 'k_cache': _w((lambda *s: torch.randn(*s, dtype=torch.bfloat16) * 1.6)(B, H, Sk, Dh)), 'v_cache': _w((lambda *s: torch.randn(*s, dtype=torch.bfloat16) * 3.2)(B, H, Sk, Dh)), 'wq': _w((lambda *s: torch.randn(*s, dtype=torch.bfloat16) * 1.6)(D, H * Dh) * D ** (-0.5)), 'wo': _w((lambda *s: torch.randn(*s, dtype=torch.bfloat16) * 3.2)(H * Dh, D) * (H * Dh) ** (-0.5))}
    _A_in = _A_setup()

    def _B_setup():
        B, S, D, F = (2, 1, 448, 1792)
        return {'x': _w((lambda *s: torch.randn(*s, dtype=torch.bfloat16) * 0.1)(B, S, D)), 'w1': _w((lambda *s: torch.randn(*s, dtype=torch.bfloat16) * 3.2)(D, F) * D ** (-0.5)), 'w2': _w((lambda *s: torch.randn(*s, dtype=torch.bfloat16) * 3.2)(F, D) * F ** (-0.5))}
    _B_in = _B_setup()
    return {'A_x': _A_in['x'], 'A_k_cache': _A_in['k_cache'], 'A_v_cache': _A_in['v_cache'], 'A_wq': _A_in['wq'], 'A_wo': _A_in['wo'], 'B_x': _B_in['x'], 'B_w1': _B_in['w1'], 'B_w2': _B_in['w2'], 'c': _w((lambda *s: torch.randn(*s, dtype=torch.bfloat16) * 0.2)(2, 448) * 8.0), 'w_mod': _w((lambda *s: torch.randn(*s, dtype=torch.bfloat16) * 0.2)(448, 6 * 448) * 448 ** (-0.5) * 8.0)}

def reference(A_x, A_k_cache, A_v_cache, A_wq, A_wo, B_x, B_w1, B_w2, c, w_mod):

    def _A_ref(x, k_cache, v_cache, wq, wo):
        B, Sq, D = x.shape
        H, Dh = (16, 256)
        q = (lambda x, *d: x.permute(*d))((x @ wq).reshape(B, Sq, H, Dh), 0, 2, 1, 3)
        scores = torch.einsum('bhqd,bhkd->bhqk', q, k_cache) * Dh ** (-0.5)
        p = _softmax(scores, axis=-1)
        o = torch.einsum('bhqk,bhkd->bhqd', p, v_cache)
        return (lambda x, *d: x.permute(*d))(o, 0, 2, 1, 3).reshape(B, Sq, H * Dh) @ wo

    def _B_ref(x, w1, w2):
        h = torch.einsum('bsd,df->bsf', x, w1)
        h = _silu(h)
        out = torch.einsum('bsf,fd->bsd', h, w2)
        return out
    x = A_x
    mod = (_silu(c) @ w_mod).reshape(c.shape[0], 6, 1, -1)
    sa, ca, ga, sb, cb, gb = (mod[:, 0].clone(), mod[:, 1].clone(), mod[:, 2].clone(), mod[:, 3].clone(), mod[:, 4].clone(), mod[:, 5].clone())
    h = _layernorm(x, axis=-1) * (1 + ca) + sa
    x = x + ga * _A_ref(h, A_k_cache, A_v_cache, A_wq, A_wo)
    h = _layernorm(x, axis=-1) * (1 + cb) + sb
    x = x + gb * _B_ref(h, B_w1, B_w2)
    return x
```

```asm
; @launch grid=(256,1,1) block=(512,1,1) lds=163840
.amdgcn_target "amdgcn-amd-amdhsa--gfx950"
.text
.globl adaLN_cond__mha_block_cached__dense_activation_silu__decode_kernel
.p2align 12
.p2align 8
.type adaLN_cond__mha_block_cached__dense_activation_silu__decode_kernel,@function
adaLN_cond__mha_block_cached__dense_activation_silu__decode_kernel:
    s_cmp_ge_u32 s2, 256
    s_cbranch_scc1 L_end
    s_load_dwordx16 s[4:19], s[0:1], 0
    s_load_dwordx8 s[20:27], s[0:1], 64
    s_load_dwordx2 s[28:29], s[0:1], 96
    v_lshrrev_b32 v1, 6, v0
    v_and_b32 v0, 63, v0
    v_readfirstlane_b32 s34, v1
    v_mov_b32 v2, 16896
    v_mov_b32 v4, 0
    v_mov_b32 v5, 0
    v_mov_b32 v6, 0
    v_mov_b32 v7, 0
    ds_write_b128 v2, v[4:7]
    ds_write_b128 v2, v[4:7] offset:16
    s_and_b32 s30, s2, 7
    s_lshr_b32 s31, s2, 3
    s_lshr_b32 s32, s2, 7
    s_and_b32 s33, s31, 15
    v_lshrrev_b32 v1, 4, v0
    v_and_b32 v2, 15, v0
    s_lshr_b32 s56, s31, 1
    s_lshl_b32 s56, s56, 3
    s_add_u32 s56, s56, s30
    s_sub_u32 s57, s56, 48
    s_cmp_lt_u32 s56, 42
    s_cselect_b32 s3, 2, 0
    s_cmp_lt_u32 s56, 14
    s_cselect_b32 s3, 4, s3
    s_cmp_lt_u32 s56, 7
    s_cselect_b32 s3, 1, s3
    s_movk_i32 s58, 0x2000
    s_cmp_lt_u32 s57, 64
    s_cselect_b32 s3, 3, s3
    s_cselect_b32 s56, s57, s56
    s_cselect_b32 s59, s58, 5376
    s_and_b32 s57, s31, 1
    s_lshl_b32 s35, s56, 1
    s_add_u32 s35, s35, s57
    s_cmp_ge_u32 s34, 4
    s_cbranch_scc1 L_stream
L_service:
    v_lshrrev_b32 v3, 5, v0
    v_and_b32 v4, 31, v0
    s_mov_b32 s72, 0x05040100
    s_mov_b32 s73, 0x07060302
    s_mov_b32 s74, 8388608
    s_setprio 3
    v_lshrrev_b32 v9, 2, v0
    s_lshl_b32 s56, s34, 4
    v_add_u32 v10, s56, v9
    s_lshl_b32 s56, s59, 3
    v_mul_u32_u24 v10, s56, v10
    v_and_b32 v11, 3, v0
    v_lshl_add_u32 v10, v11, 4, v10
    s_lshl_b32 s56, s35, 6
    v_add_u32 v8, s56, v10
    s_cmp_eq_u32 s34, 3
    s_cselect_b32 s99, 0xffff, -1
    s_mov_b32 vcc_lo, s99
    s_mov_b32 vcc_hi, s99
    v_mul_u32_u24 v11, 896, v3
    s_lshl_b32 s56, s34, 8
    v_lshl_add_u32 v5, v4, 3, v11
    v_add_u32 v5, s56, v5
    v_mov_b32 v10, 0x1000
    v_cndmask_b32 v5, v10, v5, vcc
    v_mul_u32_u24 v6, 28, v4
    v_add_u32 v6, v6, v11
    v_bfe_u32 v10, v0, 3, 1
    v_and_b32 v11, 7, v0
    v_mul_u32_u24 v7, 896, v10
    v_lshl_add_u32 v7, v11, 3, v7
    s_mul_i32 s38, s59, 448
    s_mov_b32 s39, 0x20000
    s_mov_b32 s58, 0
    s_mov_b32 s56, 0x88000
    s_waitcnt lgkmcnt(0)
    s_load_dword s100, s[28:29], s56
    s_bitcmp1_b32 30, s3
    s_cbranch_scc1 L_role
    s_barrier
    s_cmp_eq_u32 s3, 0
    s_cbranch_scc1 L_common
L_role:
    s_cmp_eq_u32 s3, 3
    s_cselect_b32 s36, s10, s22
    s_cselect_b32 s37, s11, s23
    s_cbranch_scc1 L_wload
    s_mov_b32 s48, s20
    s_mov_b32 s49, s21
    s_mov_b32 s50, 0x700
    s_mov_b32 s51, 0x20000
    buffer_load_dwordx2 v[12:13], v5, s[48:51], 0 offen
    s_cmp_lg_u32 s3, 4
    s_cbranch_scc1 L_wload
    s_mov_b32 s52, s4
    s_mov_b32 s53, s5
    s_mov_b32 s54, 0x700
    s_mov_b32 s55, 0x20000
    s_lshl_b32 s56, s35, 6
    s_sub_u32 s56, s56, 896
    buffer_load_dwordx4 v[14:17], v6, s[52:55], 0 offen
    buffer_load_dwordx3 v[18:20], v6, s[52:55], 0 offen offset:16
    buffer_load_dwordx2 v[22:23], v7, s[52:55], s56 offen
L_wload:
    buffer_load_dwordx4 v[64:67], v8, s[36:39], s58 offen nt
    s_add_u32 s58, s58, s59
    buffer_load_dwordx4 v[68:71], v8, s[36:39], s58 offen nt
    s_add_u32 s58, s58, s59
    buffer_load_dwordx4 v[72:75], v8, s[36:39], s58 offen nt
    s_add_u32 s58, s58, s59
    buffer_load_dwordx4 v[76:79], v8, s[36:39], s58 offen nt
    s_add_u32 s58, s58, s59
    buffer_load_dwordx4 v[80:83], v8, s[36:39], s58 offen nt
    s_add_u32 s58, s58, s59
    buffer_load_dwordx4 v[84:87], v8, s[36:39], s58 offen nt
    s_add_u32 s58, s58, s59
    buffer_load_dwordx4 v[88:91], v8, s[36:39], s58 offen nt
    s_add_u32 s58, s58, s59
    buffer_load_dwordx4 v[92:95], v8, s[36:39], s58 offen nt
    s_add_u32 s58, s58, s59
    s_barrier
    s_branch L_common
L_stream:
    s_sub_u32 s34, s34, 4
    s_setprio 2
    v_lshrrev_b32 v7, 2, v2
    v_and_b32 v8, 3, v2
    v_lshl_add_u32 v8, v1, 2, v8
    v_lshlrev_b32 v8, 4, v8
    v_and_b32 v9, 1, v7
    v_lshl_add_u32 v3, v9, 16, v8
    v_lshrrev_b32 v9, 1, v7
    v_lshl_add_u32 v3, v9, 21, v3
    s_lshl_b32 s48, s31, 24
    s_bfe_u32 s49, s34, 0x10000
    s_lshl_b32 s49, s49, 12
    s_xor_b32 s48, s48, s49
    s_bfe_u32 s49, s34, 0x10001
    s_lshl_b32 s49, s49, 15
    s_xor_b32 s48, s48, s49
    s_bfe_u32 s49, s30, 0x10000
    s_lshl_b32 s49, s49, 13
    s_xor_b32 s48, s48, s49
    s_bfe_u32 s49, s30, 0x20001
    s_lshl_b32 s49, s49, 10
    s_xor_b32 s48, s48, s49
    s_bfe_u32 s49, s31, 0x10000
    s_lshl_b32 s49, s49, 22
    s_xor_b32 s48, s48, s49
    s_mov_b32 s61, s48
    s_waitcnt lgkmcnt(0)
    s_mov_b32 s44, s28
    s_mov_b32 s45, s29
    s_mov_b32 s46, 0x400000
    s_mov_b32 s47, 0x20000
    s_mov_b32 s36, s6
    s_mov_b32 s37, s7
    s_mov_b32 s38, 0x20000000
    s_mov_b32 s39, 0x20000
    s_barrier
    buffer_load_dwordx4 v[64:67], v3, s[36:39], s48 offen offset:0 nt
    buffer_load_dwordx4 v[68:71], v3, s[36:39], s48 offen offset:256 nt
    s_xor_b32 s48, s48, 0x4400
    buffer_load_dwordx4 v[72:75], v3, s[36:39], s48 offen offset:0 nt
    buffer_load_dwordx4 v[76:79], v3, s[36:39], s48 offen offset:256 nt
    s_xor_b32 s48, s48, 0x4600
    buffer_load_dwordx4 v[80:83], v3, s[36:39], s48 offen offset:0 nt
    s_mov_b32 s40, s8
    s_mov_b32 s41, s9
    s_mov_b32 s42, 0x20000000
    s_mov_b32 s43, 0x20000
    s_mov_b32 s12, 0x4400
    s_mov_b32 s13, 0x4600
    s_mov_b32 s14, 0x24200
    s_mov_b32 s15, 0x424200
    s_mov_b32 s16, 0xc24200
    s_mov_b32 s17, 0xd25200
    s_mov_b32 s18, 0xda5200
    s_mov_b32 s19, 0xde5a00
    s_mov_b32 s56, 0x88000
    s_load_dword s100, s[28:29], s56
    s_add_u32 s64, s28, 0xc0000
    s_addc_u32 s65, s29, 0
    s_mov_b32 s67, 0x20000
    s_cmp_eq_u32 s34, 0
    s_cselect_b32 s71, 0x10000, 0
    s_mul_i32 s66, s71, 1
    s_mov_b32 s72, 0x75249249
    s_lshl_b32 s63, s2, 8
    s_mov_b32 s69, 0
    s_mov_b32 s4, 0x202fdfa
    s_mov_b32 s5, 0x20100803
    s_mov_b32 s6, 0xfefef6f2
    s_mov_b32 s7, 0x20160804
    s_mov_b32 s73, 0x400fefb
    s_lshl_b32 s49, s34, 12
    v_and_b32 v7, 12, v2
    v_lshl_add_u32 v7, v1, 6, v7
    v_add_u32 v5, s49, v7
    v_lshl_add_u32 v6, v0, 2, s49
    s_mul_i32 s62, s34, 32768
    s_add_u32 s62, s62, 32768
    v_and_b32 v7, 1, v2
    v_lshlrev_b32 v7, 4, v7
    v_mov_b32 v9, 0xffff
    v_lshlrev_b32 v7, v7, v9
    v_lshrrev_b32 v9, 1, v2
    v_cmp_eq_u32 vcc, 0, v9
    s_nop 1
    v_cndmask_b32 v20, 0, v7, vcc
    v_cmp_eq_u32 vcc, 1, v9
    s_nop 1
    v_cndmask_b32 v21, 0, v7, vcc
    v_cmp_eq_u32 vcc, 2, v9
    s_nop 1
    v_cndmask_b32 v22, 0, v7, vcc
    v_cmp_eq_u32 vcc, 3, v9
    s_nop 1
    v_cndmask_b32 v23, 0, v7, vcc
    s_mov_b32 s50, 0xf000f
    s_mov_b32 s51, s50
    s_mov_b32 s52, 0xf000f0
    s_mov_b32 s53, s52
    s_mov_b32 s54, 0xf000f00
    s_mov_b32 s55, s54
    s_mov_b32 s56, 0xf000f000
    s_mov_b32 s57, s56
    v_lshl_add_u32 v7, v0, 4, s62
    s_and_b32 s20, s2, 0x14
    s_bcnt1_i32_b32 s20, s20
    s_and_b32 s20, s20, 1
    s_lshl_b32 s20, s20, 3
    s_and_b32 s21, s2, 0xa
    s_bcnt1_i32_b32 s21, s21
    s_and_b32 s21, s21, 1
    s_lshr_b32 s22, s31, 2
    s_lshl_b32 s22, s22, 1
    s_add_u32 s21, s21, s22
    s_lshl_b32 s21, s21, 4
    s_add_u32 s20, s20, s21
    s_add_u32 s21, s20, s30
    s_lshl_b32 s63, s21, 8
    v_add_u32 v1, s2, v0
    v_add_u32 v1, 1, v1
    v_and_b32 v1, 7, v1
    v_lshl_add_u32 v1, v0, 5, v1
    v_add_u32 v1, s20, v1
    v_and_b32 v1, 0xff, v1
    v_lshlrev_b32 v1, 8, v1
    s_waitcnt vmcnt(4)
    buffer_load_dwordx4 v[84:87], v3, s[36:39], s48 offen offset:256 nt
    s_xor_b32 s48, s48, s12
    s_waitcnt vmcnt(4)
    buffer_load_dwordx4 v[88:91], v3, s[36:39], s48 offen offset:0 nt
    s_waitcnt vmcnt(4)
    buffer_load_dwordx4 v[92:95], v3, s[36:39], s48 offen offset:256 nt
    s_xor_b32 s48, s48, s14
    s_branch L_brk2_1s
L_brk2_1:
    s_setpc_b64 s[4:5]
L_brk2_1s:
    s_waitcnt vmcnt(4)
    buffer_load_dwordx4 v[96:99], v3, s[36:39], s48 offen offset:0 nt
    s_waitcnt vmcnt(4)
    buffer_load_dwordx4 v[100:103], v3, s[36:39], s48 offen offset:256 nt
    s_xor_b32 s48, s48, s12
    s_waitcnt vmcnt(4)
    buffer_load_dwordx4 v[104:107], v3, s[36:39], s48 offen offset:0 nt
    s_waitcnt vmcnt(4)
    buffer_load_dwordx4 v[108:111], v3, s[36:39], s48 offen offset:256 nt
    s_xor_b32 s48, s48, s13
    s_waitcnt vmcnt(4)
    buffer_load_dwordx4 v[112:115], v3, s[36:39], s48 offen offset:0 nt
    s_waitcnt vmcnt(4)
    buffer_load_dwordx4 v[116:119], v3, s[36:39], s48 offen offset:256 nt
    s_xor_b32 s48, s48, s12
    s_waitcnt vmcnt(4)
    buffer_load_dwordx4 v[120:123], v3, s[36:39], s48 offen offset:0 nt
    s_waitcnt vmcnt(4)
    buffer_load_dwordx4 v[124:127], v3, s[36:39], s48 offen offset:256 nt
    s_xor_b32 s48, s48, s15
    s_waitcnt vmcnt(4)
    buffer_load_dwordx4 v[128:131], v3, s[36:39], s48 offen offset:0 nt
    s_waitcnt vmcnt(4)
    buffer_load_dwordx4 v[132:135], v3, s[36:39], s48 offen offset:256 nt
    s_xor_b32 s48, s48, s12
    s_waitcnt vmcnt(4)
    buffer_load_dwordx4 v[136:139], v3, s[36:39], s48 offen offset:0 nt
    s_waitcnt vmcnt(4)
    buffer_load_dwordx4 v[140:143], v3, s[36:39], s48 offen offset:256 nt
    s_xor_b32 s48, s48, s13
    s_waitcnt lgkmcnt(0)
    s_mul_i32 s68, s100, 0x9e3779b1
    s_add_u32 s68, s68, 0x7f4a7c15
    v_mov_b32 v4, s68
    s_mov_b64 exec, 1
    buffer_store_dword v4, off, s[64:67], s63 sc1
    s_mov_b64 exec, -1
    s_waitcnt vmcnt(5)
    buffer_load_dwordx4 v[144:147], v3, s[36:39], s48 offen offset:0 nt
    s_mov_b64 exec, 0x7f
    buffer_load_dword v2, v1, s[64:67], 0 offen sc1
    s_mov_b64 exec, -1
    s_waitcnt vmcnt(6)
    buffer_load_dwordx4 v[148:151], v3, s[36:39], s48 offen offset:256 nt
    s_xor_b32 s48, s48, s12
    s_waitcnt vmcnt(6)
    buffer_load_dwordx4 v[152:155], v3, s[36:39], s48 offen offset:0 nt
    s_waitcnt vmcnt(6)
    buffer_load_dwordx4 v[156:159], v3, s[36:39], s48 offen offset:256 nt
    s_xor_b32 s48, s48, s14
    s_waitcnt vmcnt(6)
    buffer_load_dwordx4 v[160:163], v3, s[36:39], s48 offen offset:0 nt
    s_waitcnt vmcnt(5)
    buffer_load_dwordx4 v[164:167], v3, s[36:39], s48 offen offset:256 nt
    s_xor_b32 s48, s48, s12
    s_waitcnt vmcnt(4)
    buffer_load_dwordx4 v[168:171], v3, s[36:39], s48 offen offset:0 nt
    s_waitcnt vmcnt(4)
    buffer_load_dwordx4 v[172:175], v3, s[36:39], s48 offen offset:256 nt
    s_xor_b32 s48, s48, s13
    s_waitcnt vmcnt(4)
    buffer_load_dwordx4 v[176:179], v3, s[36:39], s48 offen offset:0 nt
    s_barrier
    s_cmp_eq_u32 s66, 0
    s_cbranch_scc1 L_nofb_2
    v_lshl_add_u32 v1, v0, 13, v1
    v_and_b32 v1, 0xffff, v1
    v_subrev_u32 v2, s68, v2
    v_cmp_gt_u32 s[22:23], 64, v2
    s_and_b32 s20, s22, 0x7f
    s_bcnt1_i32_b32 s20, s20
    s_cmp_lt_u32 s72, 2
    s_cselect_b64 s[26:27], s[6:7], s[4:5]
    s_lshl_b32 s20, s20, 3
    s_lshr_b64 s[26:27], s[26:27], s20
    s_sext_i32_i8 s26, s26
    v_mov_b32 v2, 16896
    v_mov_b32 v4, s26
    ds_write_b32 v2, v4 offset:16
L_nofb_2:
    s_add_u32 s68, s68, 1
    s_lshr_b32 s72, s72, 1
    s_bitcmp1_b32 s72, 0
    s_cselect_b32 s66, s71, 0
    s_waitcnt vmcnt(4)
    buffer_load_dwordx4 v[180:183], v3, s[36:39], s48 offen offset:256 nt
    s_xor_b32 s48, s48, s12
    s_waitcnt vmcnt(4)
    buffer_load_dwordx4 v[184:187], v3, s[36:39], s48 offen offset:0 nt
    v_mov_b32 v4, 16896
    v_mov_b32 v2, 1
    s_mov_b64 exec, 1
    ds_add_rtn_u32 v2, v4, v2 offset:20
    s_mov_b64 exec, -1
    ds_read_b32 v4, v4 offset:16
    s_waitcnt vmcnt(4)
    buffer_load_dwordx4 v[188:191], v3, s[36:39], s48 offen offset:256 nt
    s_xor_b32 s48, s48, s16
    s_waitcnt lgkmcnt(0)
    v_readfirstlane_b32 s69, v4
    v_readfirstlane_b32 s20, v2
    s_lshl_b32 s20, s20, 3
    s_lshr_b32 s20, s73, s20
    s_sext_i32_i8 s20, s20
    s_add_i32 s69, s69, s20
    s_sub_i32 s70, 0, s69
    s_cmp_gt_i32 s69, 0
    s_cbranch_scc1 L_h_3
    s_cmp_gt_i32 s70, 0
    s_cbranch_scc0 L_m_4
    s_waitcnt vmcnt(3)
L_m_4:
    s_waitcnt vmcnt(4)
L_h_3:
    s_waitcnt vmcnt(5)
    buffer_load_dwordx4 v[192:195], v3, s[36:39], s48 offen offset:0 nt
    s_cmp_gt_i32 s69, 1
    s_cbranch_scc1 L_h_5
    s_cmp_gt_i32 s70, 1
    s_cbranch_scc0 L_m_6
    s_waitcnt vmcnt(3)
L_m_6:
    s_waitcnt vmcnt(4)
L_h_5:
    s_waitcnt vmcnt(5)
    buffer_load_dwordx4 v[196:199], v3, s[36:39], s48 offen offset:256 nt
    s_xor_b32 s48, s48, s12
    s_cmp_gt_i32 s69, 2
    s_cbranch_scc1 L_h_7
    s_cmp_gt_i32 s70, 2
    s_cbranch_scc0 L_m_8
    s_waitcnt vmcnt(3)
L_m_8:
    s_waitcnt vmcnt(4)
L_h_7:
    s_waitcnt vmcnt(5)
    buffer_load_dwordx4 v[200:203], v3, s[36:39], s48 offen offset:0 nt
    s_cmp_gt_i32 s69, 3
    s_cbranch_scc1 L_h_9
    s_cmp_gt_i32 s70, 3
    s_cbranch_scc0 L_m_10
    s_waitcnt vmcnt(3)
L_m_10:
    s_waitcnt vmcnt(4)
L_h_9:
    s_waitcnt vmcnt(5)
    buffer_load_dwordx4 v[204:207], v3, s[36:39], s48 offen offset:256 nt
    s_xor_b32 s48, s48, s13
    s_cmp_gt_i32 s69, 4
    s_cbranch_scc1 L_h_11
    s_cmp_gt_i32 s70, 4
    s_cbranch_scc0 L_m_12
    s_waitcnt vmcnt(3)
L_m_12:
    s_waitcnt vmcnt(4)
L_h_11:
    s_waitcnt vmcnt(5)
    buffer_load_dwordx4 v[208:211], v3, s[36:39], s48 offen offset:0 nt
    s_cmp_gt_i32 s69, 5
    s_cbranch_scc1 L_h_13
    s_cmp_gt_i32 s70, 5
    s_cbranch_scc0 L_m_14
    s_waitcnt vmcnt(3)
L_m_14:
    s_waitcnt vmcnt(4)
L_h_13:
    s_waitcnt vmcnt(5)
    buffer_load_dwordx4 v[212:215], v3, s[36:39], s48 offen offset:256 nt
    s_xor_b32 s48, s48, s12
    s_cmp_gt_i32 s69, 6
    s_cbranch_scc1 L_h_15
    s_cmp_gt_i32 s70, 6
    s_cbranch_scc0 L_m_16
    s_waitcnt vmcnt(3)
L_m_16:
    s_waitcnt vmcnt(4)
L_h_15:
    s_waitcnt vmcnt(5)
    buffer_load_dwordx4 v[216:219], v3, s[36:39], s48 offen offset:0 nt
    s_cmp_gt_i32 s69, 7
    s_cbranch_scc1 L_h_17
    s_cmp_gt_i32 s70, 7
    s_cbranch_scc0 L_m_18
    s_waitcnt vmcnt(3)
L_m_18:
    s_waitcnt vmcnt(4)
L_h_17:
    s_waitcnt vmcnt(5)
    buffer_load_dwordx4 v[220:223], v3, s[36:39], s48 offen offset:256 nt
    s_xor_b32 s48, s48, s14
    s_branch L_brk2_19s
.p2align 12
L_brk2_19:
    s_setpc_b64 s[4:5]
L_brk2_19s:
    s_cmp_gt_i32 s69, 8
    s_cbranch_scc1 L_h_20
    s_cmp_gt_i32 s70, 8
    s_cbranch_scc0 L_m_21
    s_waitcnt vmcnt(3)
L_m_21:
    s_waitcnt vmcnt(4)
L_h_20:
    s_waitcnt vmcnt(5)
    buffer_load_dwordx4 v[224:227], v3, s[36:39], s48 offen offset:0 nt
    s_cmp_gt_i32 s69, 9
    s_cbranch_scc1 L_h_22
    s_cmp_gt_i32 s70, 9
    s_cbranch_scc0 L_m_23
    s_waitcnt vmcnt(3)
L_m_23:
    s_waitcnt vmcnt(4)
L_h_22:
    s_waitcnt vmcnt(5)
    buffer_load_dwordx4 v[228:231], v3, s[36:39], s48 offen offset:256 nt
    s_xor_b32 s48, s48, s12
    s_cmp_gt_i32 s69, 10
    s_cbranch_scc1 L_h_24
    s_cmp_gt_i32 s70, 10
    s_cbranch_scc0 L_m_25
    s_waitcnt vmcnt(3)
L_m_25:
    s_waitcnt vmcnt(4)
L_h_24:
    s_waitcnt vmcnt(5)
    buffer_load_dwordx4 v[232:235], v3, s[36:39], s48 offen offset:0 nt
    s_cmp_gt_i32 s69, 11
    s_cbranch_scc1 L_h_26
    s_cmp_gt_i32 s70, 11
    s_cbranch_scc0 L_m_27
    s_waitcnt vmcnt(3)
L_m_27:
    s_waitcnt vmcnt(4)
L_h_26:
    s_waitcnt vmcnt(5)
    buffer_load_dwordx4 v[236:239], v3, s[36:39], s48 offen offset:256 nt
    s_xor_b32 s48, s48, s13
    s_cmp_gt_i32 s69, 12
    s_cbranch_scc1 L_h_28
    s_cmp_gt_i32 s70, 12
    s_cbranch_scc0 L_m_29
    s_waitcnt vmcnt(3)
L_m_29:
    s_waitcnt vmcnt(4)
L_h_28:
    s_waitcnt vmcnt(5)
    buffer_load_dwordx4 v[240:243], v3, s[36:39], s48 offen offset:0 nt
    s_cmp_gt_i32 s69, 13
    s_cbranch_scc1 L_h_30
    s_cmp_gt_i32 s70, 13
    s_cbranch_scc0 L_m_31
    s_waitcnt vmcnt(3)
L_m_31:
    s_waitcnt vmcnt(4)
L_h_30:
    s_waitcnt vmcnt(5)
    buffer_load_dwordx4 v[244:247], v3, s[36:39], s48 offen offset:256 nt
    s_xor_b32 s48, s48, s12
    s_cmp_gt_i32 s69, 14
    s_cbranch_scc1 L_h_32
    s_cmp_gt_i32 s70, 14
    s_cbranch_scc0 L_m_33
    s_waitcnt vmcnt(3)
L_m_33:
    s_waitcnt vmcnt(4)
L_h_32:
    s_waitcnt vmcnt(5)
    buffer_load_dwordx4 v[248:251], v3, s[36:39], s48 offen offset:0 nt
    s_cmp_gt_i32 s69, 15
    s_cbranch_scc1 L_h_34
    s_cmp_gt_i32 s70, 15
    s_cbranch_scc0 L_m_35
    s_waitcnt vmcnt(3)
L_m_35:
    s_waitcnt vmcnt(4)
L_h_34:
    s_waitcnt vmcnt(5)
    buffer_load_dwordx4 v[252:255], v3, s[36:39], s48 offen offset:256 nt
    s_xor_b32 s48, s48, s15
    s_add_u32 m0, s62, 0
    s_cmp_gt_i32 s69, 16
    s_cbranch_scc1 L_h_36
    s_waitcnt vmcnt(4)
L_h_36:
    s_waitcnt vmcnt(5)
    buffer_load_dwordx4 v3, s[36:39], s48 offen offset:0 nt lds
    s_add_u32 m0, s62, 768
    s_cmp_gt_i32 s69, 17
    s_cbranch_scc1 L_h_38
    s_waitcnt vmcnt(4)
L_h_38:
    s_waitcnt vmcnt(5)
    buffer_load_dwordx4 v3, s[36:39], s48 offen offset:256 nt lds
    s_xor_b32 s48, s48, s12
    s_add_u32 m0, s62, 2048
    s_cmp_gt_i32 s69, 18
    s_cbranch_scc1 L_h_40
    s_waitcnt vmcnt(4)
L_h_40:
    s_waitcnt vmcnt(5)
    buffer_load_dwordx4 v3, s[36:39], s48 offen offset:0 nt lds
    s_add_u32 m0, s62, 2816
    s_cmp_gt_i32 s69, 19
    s_cbranch_scc1 L_h_42
    s_waitcnt vmcnt(4)
L_h_42:
    s_waitcnt vmcnt(5)
    buffer_load_dwordx4 v3, s[36:39], s48 offen offset:256 nt lds
    s_xor_b32 s48, s48, s13
    v_mov_b32 v4, s68
    s_mov_b64 exec, 1
    buffer_store_dword v4, off, s[64:67], s63 sc1
    s_mov_b64 exec, -1
    s_add_u32 m0, s62, 4096
    s_cmp_gt_i32 s69, 20
    s_cbranch_scc1 L_h_44
    s_waitcnt vmcnt(5)
L_h_44:
    s_waitcnt vmcnt(6)
    buffer_load_dwordx4 v3, s[36:39], s48 offen offset:0 nt lds
    s_mov_b64 exec, 0x7f
    buffer_load_dword v2, v1, s[64:67], 0 offen sc1
    s_mov_b64 exec, -1
    s_add_u32 m0, s62, 4864
    s_cmp_gt_i32 s69, 21
    s_cbranch_scc1 L_h_46
    s_waitcnt vmcnt(6)
L_h_46:
    s_waitcnt vmcnt(7)
    buffer_load_dwordx4 v3, s[36:39], s48 offen offset:256 nt lds
    s_xor_b32 s48, s48, s12
    s_add_u32 m0, s62, 6144
    s_cmp_gt_i32 s69, 22
    s_cbranch_scc1 L_h_48
    s_waitcnt vmcnt(6)
L_h_48:
    s_waitcnt vmcnt(7)
    buffer_load_dwordx4 v3, s[36:39], s48 offen offset:0 nt lds
    s_add_u32 m0, s62, 6912
    s_cmp_gt_i32 s69, 23
    s_cbranch_scc1 L_h_50
    s_waitcnt vmcnt(6)
L_h_50:
    s_waitcnt vmcnt(7)
    buffer_load_dwordx4 v3, s[36:39], s48 offen offset:256 nt lds
    s_xor_b32 s48, s48, s14
    s_add_u32 m0, s62, 8192
    s_cmp_gt_i32 s69, 24
    s_cbranch_scc1 L_h_52
    s_waitcnt vmcnt(6)
L_h_52:
    s_waitcnt vmcnt(7)
    buffer_load_dwordx4 v3, s[36:39], s48 offen offset:0 nt lds
    s_add_u32 m0, s62, 8960
    s_cmp_gt_i32 s69, 25
    s_cbranch_scc1 L_h_54
    s_waitcnt vmcnt(5)
L_h_54:
    s_waitcnt vmcnt(7)
    buffer_load_dwordx4 v3, s[36:39], s48 offen offset:256 nt lds
    s_xor_b32 s48, s48, s12
    s_add_u32 m0, s62, 10240
    s_cmp_gt_i32 s69, 26
    s_cbranch_scc1 L_h_56
    s_waitcnt vmcnt(4)
L_h_56:
    s_waitcnt vmcnt(6)
    buffer_load_dwordx4 v3, s[36:39], s48 offen offset:0 nt lds
    s_add_u32 m0, s62, 11008
    s_cmp_gt_i32 s69, 27
    s_cbranch_scc1 L_h_58
    s_waitcnt vmcnt(4)
L_h_58:
    s_waitcnt vmcnt(5)
    buffer_load_dwordx4 v3, s[36:39], s48 offen offset:256 nt lds
    s_xor_b32 s48, s48, s13
    s_add_u32 m0, s62, 12288
    s_cmp_gt_i32 s69, 28
    s_cbranch_scc1 L_h_60
    s_waitcnt vmcnt(4)
L_h_60:
    s_waitcnt vmcnt(5)
    buffer_load_dwordx4 v3, s[36:39], s48 offen offset:0 nt lds
    s_barrier
    s_cmp_eq_u32 s66, 0
    s_cbranch_scc1 L_nofb_62
    v_lshl_add_u32 v1, v0, 13, v1
    v_and_b32 v1, 0xffff, v1
    v_subrev_u32 v2, s68, v2
    v_cmp_gt_u32 s[22:23], 64, v2
    s_and_b32 s20, s22, 0x7f
    s_bcnt1_i32_b32 s20, s20
    s_cmp_lt_u32 s72, 2
    s_cselect_b64 s[26:27], s[6:7], s[4:5]
    s_lshl_b32 s20, s20, 3
    s_lshr_b64 s[26:27], s[26:27], s20
    s_sext_i32_i8 s26, s26
    v_mov_b32 v2, 16896
    v_mov_b32 v4, s26
    ds_write_b32 v2, v4 offset:16
L_nofb_62:
    s_add_u32 s68, s68, 1
    s_lshr_b32 s72, s72, 1
    s_bitcmp1_b32 s72, 0
    s_cselect_b32 s66, s71, 0
    s_add_u32 m0, s62, 13056
    s_cmp_gt_i32 s69, 29
    s_cbranch_scc1 L_h_63
    s_waitcnt vmcnt(4)
L_h_63:
    s_waitcnt vmcnt(5)
    buffer_load_dwordx4 v3, s[36:39], s48 offen offset:256 nt lds
    s_xor_b32 s48, s48, s12
    s_add_u32 m0, s62, 14336
    s_cmp_gt_i32 s69, 30
    s_cbranch_scc1 L_h_65
    s_waitcnt vmcnt(4)
L_h_65:
    s_waitcnt vmcnt(5)
    buffer_load_dwordx4 v3, s[36:39], s48 offen offset:0 nt lds
    v_mov_b32 v4, 16896
    v_mov_b32 v2, 1
    s_mov_b64 exec, 1
    ds_add_rtn_u32 v2, v4, v2 offset:20
    s_mov_b64 exec, -1
    ds_read_b32 v4, v4 offset:16
    s_add_u32 m0, s62, 15104
    s_cmp_gt_i32 s69, 31
    s_cbranch_scc1 L_h_67
    s_waitcnt vmcnt(4)
L_h_67:
    s_waitcnt vmcnt(5)
    buffer_load_dwordx4 v3, s[36:39], s48 offen offset:256 nt lds
    s_xor_b32 s48, s48, s17
    s_waitcnt lgkmcnt(0)
    v_readfirstlane_b32 s69, v4
    v_readfirstlane_b32 s20, v2
    s_lshl_b32 s20, s20, 3
    s_lshr_b32 s20, s73, s20
    s_sext_i32_i8 s20, s20
    s_add_i32 s69, s69, s20
    s_sub_i32 s70, 0, s69
    s_add_u32 m0, s62, 16384
    s_cmp_gt_i32 s69, 0
    s_cbranch_scc1 L_h_69
    s_cmp_gt_i32 s70, 0
    s_cbranch_scc0 L_m_70
    s_waitcnt vmcnt(3)
L_m_70:
    s_waitcnt vmcnt(4)
L_h_69:
    s_waitcnt vmcnt(5)
    buffer_load_dwordx4 v3, s[36:39], s48 offen offset:0 nt lds
    s_add_u32 m0, s62, 17152
    s_cmp_gt_i32 s69, 1
    s_cbranch_scc1 L_h_71
    s_cmp_gt_i32 s70, 1
    s_cbranch_scc0 L_m_72
    s_waitcnt vmcnt(3)
L_m_72:
    s_waitcnt vmcnt(4)
L_h_71:
    s_waitcnt vmcnt(5)
    buffer_load_dwordx4 v3, s[36:39], s48 offen offset:256 nt lds
    s_xor_b32 s48, s48, s12
    s_add_u32 m0, s62, 18432
    s_cmp_gt_i32 s69, 2
    s_cbranch_scc1 L_h_73
    s_cmp_gt_i32 s70, 2
    s_cbranch_scc0 L_m_74
    s_waitcnt vmcnt(3)
L_m_74:
    s_waitcnt vmcnt(4)
L_h_73:
    s_waitcnt vmcnt(5)
    buffer_load_dwordx4 v3, s[36:39], s48 offen offset:0 nt lds
    s_add_u32 m0, s62, 19200
    s_cmp_gt_i32 s69, 3
    s_cbranch_scc1 L_h_75
    s_cmp_gt_i32 s70, 3
    s_cbranch_scc0 L_m_76
    s_waitcnt vmcnt(3)
L_m_76:
    s_waitcnt vmcnt(4)
L_h_75:
    s_waitcnt vmcnt(5)
    buffer_load_dwordx4 v3, s[36:39], s48 offen offset:256 nt lds
    s_xor_b32 s48, s48, s13
    s_add_u32 m0, s62, 20480
    s_cmp_gt_i32 s69, 4
    s_cbranch_scc1 L_h_77
    s_cmp_gt_i32 s70, 4
    s_cbranch_scc0 L_m_78
    s_waitcnt vmcnt(3)
L_m_78:
    s_waitcnt vmcnt(4)
L_h_77:
    s_waitcnt vmcnt(5)
    buffer_load_dwordx4 v3, s[36:39], s48 offen offset:0 nt lds
    s_add_u32 m0, s62, 21248
    s_cmp_gt_i32 s69, 5
    s_cbranch_scc1 L_h_79
    s_cmp_gt_i32 s70, 5
    s_cbranch_scc0 L_m_80
    s_waitcnt vmcnt(3)
L_m_80:
    s_waitcnt vmcnt(4)
L_h_79:
    s_waitcnt vmcnt(5)
    buffer_load_dwordx4 v3, s[36:39], s48 offen offset:256 nt lds
    s_xor_b32 s48, s48, s12
    s_add_u32 m0, s62, 22528
    s_cmp_gt_i32 s69, 6
    s_cbranch_scc1 L_h_81
    s_cmp_gt_i32 s70, 6
    s_cbranch_scc0 L_m_82
    s_waitcnt vmcnt(3)
L_m_82:
    s_waitcnt vmcnt(4)
L_h_81:
    s_waitcnt vmcnt(5)
    buffer_load_dwordx4 v3, s[36:39], s48 offen offset:0 nt lds
    s_add_u32 m0, s62, 23296
    s_cmp_gt_i32 s69, 7
    s_cbranch_scc1 L_h_83
    s_cmp_gt_i32 s70, 7
    s_cbranch_scc0 L_m_84
    s_waitcnt vmcnt(3)
L_m_84:
    s_waitcnt vmcnt(4)
L_h_83:
    s_waitcnt vmcnt(5)
    buffer_load_dwordx4 v3, s[36:39], s48 offen offset:256 nt lds
    s_xor_b32 s48, s48, s14
    s_branch L_brk2_85s
L_brk2_85:
    s_setpc_b64 s[4:5]
L_brk2_85s:
    s_add_u32 m0, s62, 24576
    s_cmp_gt_i32 s69, 8
    s_cbranch_scc1 L_h_86
    s_cmp_gt_i32 s70, 8
    s_cbranch_scc0 L_m_87
    s_waitcnt vmcnt(3)
L_m_87:
    s_waitcnt vmcnt(4)
L_h_86:
    s_waitcnt vmcnt(5)
    buffer_load_dwordx4 v3, s[36:39], s48 offen offset:0 nt lds
    s_add_u32 m0, s62, 25344
    s_cmp_gt_i32 s69, 9
    s_cbranch_scc1 L_h_88
    s_cmp_gt_i32 s70, 9
    s_cbranch_scc0 L_m_89
    s_waitcnt vmcnt(3)
L_m_89:
    s_waitcnt vmcnt(4)
L_h_88:
    s_waitcnt vmcnt(5)
    buffer_load_dwordx4 v3, s[36:39], s48 offen offset:256 nt lds
    s_xor_b32 s48, s48, s12
    s_add_u32 m0, s62, 26624
    s_cmp_gt_i32 s69, 10
    s_cbranch_scc1 L_h_90
    s_cmp_gt_i32 s70, 10
    s_cbranch_scc0 L_m_91
    s_waitcnt vmcnt(3)
L_m_91:
    s_waitcnt vmcnt(4)
L_h_90:
    s_waitcnt vmcnt(5)
    buffer_load_dwordx4 v3, s[36:39], s48 offen offset:0 nt lds
    s_add_u32 m0, s62, 27392
    s_cmp_gt_i32 s69, 11
    s_cbranch_scc1 L_h_92
    s_cmp_gt_i32 s70, 11
    s_cbranch_scc0 L_m_93
    s_waitcnt vmcnt(3)
L_m_93:
    s_waitcnt vmcnt(4)
L_h_92:
    s_waitcnt vmcnt(5)
    buffer_load_dwordx4 v3, s[36:39], s48 offen offset:256 nt lds
    s_xor_b32 s48, s48, s13
    s_branch L_brk1_94s
L_brk1_94:
    s_setpc_b64 s[4:5]
L_brk1_94s:
    s_barrier
    ds_read_b128 v[24:27], v8 offset:16384
    ds_read_b128 v[28:31], v8 offset:16640
    s_add_u32 m0, s62, 28672
    s_cmp_gt_i32 s69, 12
    s_cbranch_scc1 L_h_95
    s_cmp_gt_i32 s70, 12
    s_cbranch_scc0 L_m_96
    s_waitcnt vmcnt(3)
L_m_96:
    s_waitcnt vmcnt(4)
L_h_95:
    s_waitcnt vmcnt(5)
    buffer_load_dwordx4 v3, s[36:39], s48 offen offset:0 nt lds
    s_add_u32 m0, s62, 29440
    s_cmp_gt_i32 s69, 13
    s_cbranch_scc1 L_h_97
    s_cmp_gt_i32 s70, 13
    s_cbranch_scc0 L_m_98
    s_waitcnt vmcnt(3)
L_m_98:
    s_waitcnt vmcnt(4)
L_h_97:
    s_waitcnt vmcnt(5)
    buffer_load_dwordx4 v3, s[36:39], s48 offen offset:256 nt lds
    s_xor_b32 s48, s48, s12
    s_add_u32 m0, s62, 30720
    s_cmp_gt_i32 s69, 14
    s_cbranch_scc1 L_h_99
    s_cmp_gt_i32 s70, 14
    s_cbranch_scc0 L_m_100
    s_waitcnt vmcnt(3)
L_m_100:
    s_waitcnt vmcnt(4)
L_h_99:
    s_waitcnt vmcnt(5)
    buffer_load_dwordx4 v3, s[36:39], s48 offen offset:0 nt lds
    s_add_u32 m0, s62, 31488
    s_cmp_gt_i32 s69, 15
    s_cbranch_scc1 L_h_101
    s_cmp_gt_i32 s70, 15
    s_cbranch_scc0 L_m_102
    s_waitcnt vmcnt(3)
L_m_102:
    s_waitcnt vmcnt(4)
L_h_101:
    s_waitcnt vmcnt(5)
    buffer_load_dwordx4 v3, s[36:39], s48 offen offset:256 nt lds
    s_xor_b32 s48, s48, s15
    s_waitcnt lgkmcnt(0)
    v_cndmask_b32 v32, 0, v24, s[50:51]
    v_cndmask_b32 v33, 0, v25, s[50:51]
    v_cndmask_b32 v34, 0, v26, s[50:51]
    v_cndmask_b32 v35, 0, v27, s[50:51]
    v_cndmask_b32 v36, 0, v28, s[50:51]
    v_cndmask_b32 v37, 0, v29, s[50:51]
    v_cndmask_b32 v38, 0, v30, s[50:51]
    v_cndmask_b32 v39, 0, v31, s[50:51]
    v_cndmask_b32 v40, 0, v24, s[52:53]
    v_cndmask_b32 v41, 0, v25, s[52:53]
    v_cndmask_b32 v42, 0, v26, s[52:53]
    v_cndmask_b32 v43, 0, v27, s[52:53]
    v_cndmask_b32 v44, 0, v28, s[52:53]
    v_cndmask_b32 v45, 0, v29, s[52:53]
    v_cndmask_b32 v46, 0, v30, s[52:53]
    v_cndmask_b32 v47, 0, v31, s[52:53]
    v_cndmask_b32 v48, 0, v24, s[54:55]
    v_cndmask_b32 v49, 0, v25, s[54:55]
    v_cndmask_b32 v50, 0, v26, s[54:55]
    v_cndmask_b32 v51, 0, v27, s[54:55]
    v_cndmask_b32 v52, 0, v28, s[54:55]
    v_cndmask_b32 v53, 0, v29, s[54:55]
    v_cndmask_b32 v54, 0, v30, s[54:55]
    v_cndmask_b32 v55, 0, v31, s[54:55]
    v_cndmask_b32 v56, 0, v24, s[56:57]
    v_cndmask_b32 v57, 0, v25, s[56:57]
    v_cndmask_b32 v58, 0, v26, s[56:57]
    v_cndmask_b32 v59, 0, v27, s[56:57]
    v_cndmask_b32 v60, 0, v28, s[56:57]
    v_cndmask_b32 v61, 0, v29, s[56:57]
    v_cndmask_b32 v62, 0, v30, s[56:57]
    v_cndmask_b32 v63, 0, v31, s[56:57]
    v_mfma_f32_16x16x32_bf16 v[8:11], v[64:67], v[32:35], 0
    s_cmp_gt_i32 s69, 16
    s_cbranch_scc1 L_h_103
    s_waitcnt vmcnt(4)
L_h_103:
    s_waitcnt vmcnt(5)
    buffer_load_dwordx4 v[64:67], v3, s[36:39], s48 offen offset:0 nt
    v_mfma_f32_16x16x32_bf16 v[8:11], v[68:71], v[36:39], v[8:11]
    s_cmp_gt_i32 s69, 17
    s_cbranch_scc1 L_h_105
    s_waitcnt vmcnt(4)
L_h_105:
    s_waitcnt vmcnt(5)
    buffer_load_dwordx4 v[68:71], v3, s[36:39], s48 offen offset:256 nt
    s_xor_b32 s48, s48, s12
    v_mfma_f32_16x16x32_bf16 v[8:11], v[72:75], v[40:43], v[8:11]
    s_cmp_gt_i32 s69, 18
    s_cbranch_scc1 L_h_107
    s_waitcnt vmcnt(4)
L_h_107:
    s_waitcnt vmcnt(5)
    buffer_load_dwordx4 v[72:75], v3, s[36:39], s48 offen offset:0 nt
    v_mfma_f32_16x16x32_bf16 v[8:11], v[76:79], v[44:47], v[8:11]
    s_cmp_gt_i32 s69, 19
    s_cbranch_scc1 L_h_109
    s_waitcnt vmcnt(4)
L_h_109:
    s_waitcnt vmcnt(5)
    buffer_load_dwordx4 v[76:79], v3, s[36:39], s48 offen offset:256 nt
    s_xor_b32 s48, s48, s13
    v_mov_b32 v4, s68
    s_mov_b64 exec, 1
    buffer_store_dword v4, off, s[64:67], s63 sc1
    s_mov_b64 exec, -1
    v_mfma_f32_16x16x32_bf16 v[8:11], v[80:83], v[48:51], v[8:11]
    s_cmp_gt_i32 s69, 20
    s_cbranch_scc1 L_h_111
    s_waitcnt vmcnt(5)
L_h_111:
    s_waitcnt vmcnt(6)
    buffer_load_dwordx4 v[80:83], v3, s[36:39], s48 offen offset:0 nt
    s_mov_b64 exec, 0x7f
    buffer_load_dword v2, v1, s[64:67], 0 offen sc1
    s_mov_b64 exec, -1
    v_mfma_f32_16x16x32_bf16 v[8:11], v[84:87], v[52:55], v[8:11]
    v_mfma_f32_16x16x32_bf16 v[8:11], v[88:91], v[56:59], v[8:11]
    v_mfma_f32_16x16x32_bf16 v[8:11], v[92:95], v[60:63], v[8:11]
    v_mfma_f32_16x16x32_bf16 v[12:15], v[96:99], v[32:35], 0
    v_mfma_f32_16x16x32_bf16 v[12:15], v[100:103], v[36:39], v[12:15]
    s_nop 5
    v_mov_b32_dpp v16, v8 quad_perm:[0,0,0,0] row_mask:0xf bank_mask:0xf
    v_mfma_f32_16x16x32_bf16 v[12:15], v[104:107], v[40:43], v[12:15]
    v_mov_b32_dpp v17, v9 quad_perm:[1,1,1,1] row_mask:0xf bank_mask:0xf
    v_mfma_f32_16x16x32_bf16 v[12:15], v[108:111], v[44:47], v[12:15]
    v_add_f32_dpp v16, v10, v16 quad_perm:[2,2,2,2] row_mask:0xf bank_mask:0xf
    v_mfma_f32_16x16x32_bf16 v[12:15], v[112:115], v[48:51], v[12:15]
    v_add_f32_dpp v17, v11, v17 quad_perm:[3,3,3,3] row_mask:0xf bank_mask:0xf
    s_cmp_gt_i32 s69, 21
    s_cbranch_scc1 L_h_113
    s_waitcnt vmcnt(6)
L_h_113:
    s_waitcnt vmcnt(7)
    buffer_load_dwordx4 v[84:87], v3, s[36:39], s48 offen offset:256 nt
    s_xor_b32 s48, s48, s12
    v_mfma_f32_16x16x32_bf16 v[12:15], v[116:119], v[52:55], v[12:15]
    v_add_f32 v16, v16, v17
    v_mfma_f32_16x16x32_bf16 v[12:15], v[120:123], v[56:59], v[12:15]
    ds_write_b32 v5, v16 offset:0
    v_mfma_f32_16x16x32_bf16 v[12:15], v[124:127], v[60:63], v[12:15]
    v_mfma_f32_16x16x32_bf16 v[8:11], v[128:131], v[32:35], 0
    v_mfma_f32_16x16x32_bf16 v[8:11], v[132:135], v[36:39], v[8:11]
    s_nop 5
    v_mov_b32_dpp v16, v12 quad_perm:[0,0,0,0] row_mask:0xf bank_mask:0xf
    v_mfma_f32_16x16x32_bf16 v[8:11], v[136:139], v[40:43], v[8:11]
    v_mov_b32_dpp v17, v13 quad_perm:[1,1,1,1] row_mask:0xf bank_mask:0xf
    v_mfma_f32_16x16x32_bf16 v[8:11], v[140:143], v[44:47], v[8:11]
    v_add_f32_dpp v16, v14, v16 quad_perm:[2,2,2,2] row_mask:0xf bank_mask:0xf
    v_mfma_f32_16x16x32_bf16 v[8:11], v[144:147], v[48:51], v[8:11]
    v_add_f32_dpp v17, v15, v17 quad_perm:[3,3,3,3] row_mask:0xf bank_mask:0xf
    s_cmp_gt_i32 s69, 22
    s_cbranch_scc1 L_h_115
    s_waitcnt vmcnt(6)
L_h_115:
    s_waitcnt vmcnt(7)
    buffer_load_dwordx4 v[88:91], v3, s[36:39], s48 offen offset:0 nt
    v_mfma_f32_16x16x32_bf16 v[8:11], v[148:151], v[52:55], v[8:11]
    v_add_f32 v16, v16, v17
    v_mfma_f32_16x16x32_bf16 v[8:11], v[152:155], v[56:59], v[8:11]
    ds_write_b32 v5, v16 offset:16
    v_mfma_f32_16x16x32_bf16 v[8:11], v[156:159], v[60:63], v[8:11]
    v_mfma_f32_16x16x32_bf16 v[12:15], v[160:163], v[32:35], 0
    v_mfma_f32_16x16x32_bf16 v[12:15], v[164:167], v[36:39], v[12:15]
    s_nop 5
    v_mov_b32_dpp v16, v8 quad_perm:[0,0,0,0] row_mask:0xf bank_mask:0xf
    v_mfma_f32_16x16x32_bf16 v[12:15], v[168:171], v[40:43], v[12:15]
    v_mov_b32_dpp v17, v9 quad_perm:[1,1,1,1] row_mask:0xf bank_mask:0xf
    v_mfma_f32_16x16x32_bf16 v[12:15], v[172:175], v[44:47], v[12:15]
    v_add_f32_dpp v16, v10, v16 quad_perm:[2,2,2,2] row_mask:0xf bank_mask:0xf
    v_mfma_f32_16x16x32_bf16 v[12:15], v[176:179], v[48:51], v[12:15]
    v_add_f32_dpp v17, v11, v17 quad_perm:[3,3,3,3] row_mask:0xf bank_mask:0xf
    s_cmp_gt_i32 s69, 23
    s_cbranch_scc1 L_h_117
    s_waitcnt vmcnt(6)
L_h_117:
    s_waitcnt vmcnt(7)
    buffer_load_dwordx4 v[92:95], v3, s[36:39], s48 offen offset:256 nt
    s_xor_b32 s48, s48, s14
    v_mfma_f32_16x16x32_bf16 v[12:15], v[180:183], v[52:55], v[12:15]
    v_add_f32 v16, v16, v17
    v_mfma_f32_16x16x32_bf16 v[12:15], v[184:187], v[56:59], v[12:15]
    ds_write_b32 v5, v16 offset:32
    v_mfma_f32_16x16x32_bf16 v[12:15], v[188:191], v[60:63], v[12:15]
    v_mfma_f32_16x16x32_bf16 v[8:11], v[192:195], v[32:35], 0
    v_mfma_f32_16x16x32_bf16 v[8:11], v[196:199], v[36:39], v[8:11]
    s_nop 5
    v_mov_b32_dpp v16, v12 quad_perm:[0,0,0,0] row_mask:0xf bank_mask:0xf
    v_mfma_f32_16x16x32_bf16 v[8:11], v[200:203], v[40:43], v[8:11]
    v_mov_b32_dpp v17, v13 quad_perm:[1,1,1,1] row_mask:0xf bank_mask:0xf
    v_mfma_f32_16x16x32_bf16 v[8:11], v[204:207], v[44:47], v[8:11]
    v_add_f32_dpp v16, v14, v16 quad_perm:[2,2,2,2] row_mask:0xf bank_mask:0xf
    v_mfma_f32_16x16x32_bf16 v[8:11], v[208:211], v[48:51], v[8:11]
    v_add_f32_dpp v17, v15, v17 quad_perm:[3,3,3,3] row_mask:0xf bank_mask:0xf
    s_cmp_gt_i32 s69, 24
    s_cbranch_scc1 L_h_119
    s_waitcnt vmcnt(6)
L_h_119:
    s_waitcnt vmcnt(7)
    buffer_load_dwordx4 v[96:99], v3, s[36:39], s48 offen offset:0 nt
    s_branch L_brk1_121s
L_brk1_121:
    s_setpc_b64 s[4:5]
L_brk1_121s:
    v_mfma_f32_16x16x32_bf16 v[8:11], v[212:215], v[52:55], v[8:11]
    v_add_f32 v16, v16, v17
    v_mfma_f32_16x16x32_bf16 v[8:11], v[216:219], v[56:59], v[8:11]
    ds_write_b32 v5, v16 offset:48
    v_mfma_f32_16x16x32_bf16 v[8:11], v[220:223], v[60:63], v[8:11]
    ds_read_b128 v[128:131], v7 offset:0
    v_mfma_f32_16x16x32_bf16 v[12:15], v[224:227], v[32:35], 0
    ds_read_b128 v[132:135], v7 offset:1024
    v_mfma_f32_16x16x32_bf16 v[12:15], v[228:231], v[36:39], v[12:15]
    s_nop 3
    v_mov_b32_dpp v16, v8 quad_perm:[0,0,0,0] row_mask:0xf bank_mask:0xf
    ds_read_b128 v[136:139], v7 offset:2048
    v_mfma_f32_16x16x32_bf16 v[12:15], v[232:235], v[40:43], v[12:15]
    v_mov_b32_dpp v17, v9 quad_perm:[1,1,1,1] row_mask:0xf bank_mask:0xf
    ds_read_b128 v[140:143], v7 offset:3072
    v_mfma_f32_16x16x32_bf16 v[12:15], v[236:239], v[44:47], v[12:15]
    v_add_f32_dpp v16, v10, v16 quad_perm:[2,2,2,2] row_mask:0xf bank_mask:0xf
    ds_read_b128 v[144:147], v7 offset:4096
    v_mfma_f32_16x16x32_bf16 v[12:15], v[240:243], v[48:51], v[12:15]
    v_add_f32_dpp v17, v11, v17 quad_perm:[3,3,3,3] row_mask:0xf bank_mask:0xf
    s_cmp_gt_i32 s69, 25
    s_cbranch_scc1 L_h_122
    s_waitcnt vmcnt(5)
L_h_122:
    s_waitcnt vmcnt(7)
    buffer_load_dwordx4 v[100:103], v3, s[36:39], s48 offen offset:256 nt
    s_xor_b32 s48, s48, s12
    ds_read_b128 v[148:151], v7 offset:5120
    v_mfma_f32_16x16x32_bf16 v[12:15], v[244:247], v[52:55], v[12:15]
    v_add_f32 v16, v16, v17
    ds_read_b128 v[152:155], v7 offset:6144
    v_mfma_f32_16x16x32_bf16 v[12:15], v[248:251], v[56:59], v[12:15]
    ds_write_b32 v5, v16 offset:256
    ds_read_b128 v[156:159], v7 offset:7168
    v_mfma_f32_16x16x32_bf16 v[12:15], v[252:255], v[60:63], v[12:15]
    ds_read_b128 v[160:163], v7 offset:8192
    s_waitcnt lgkmcnt(5)
    v_mfma_f32_16x16x32_bf16 v[8:11], v[128:131], v[32:35], 0
    ds_read_b128 v[164:167], v7 offset:9216
    v_mfma_f32_16x16x32_bf16 v[8:11], v[132:135], v[36:39], v[8:11]
    s_nop 2
    v_mov_b32_dpp v16, v12 quad_perm:[0,0,0,0] row_mask:0xf bank_mask:0xf
    ds_read_b128 v[168:171], v7 offset:10240
    v_mfma_f32_16x16x32_bf16 v[8:11], v[136:139], v[40:43], v[8:11]
    v_mov_b32_dpp v17, v13 quad_perm:[1,1,1,1] row_mask:0xf bank_mask:0xf
    ds_read_b128 v[172:175], v7 offset:11264
    v_mfma_f32_16x16x32_bf16 v[8:11], v[140:143], v[44:47], v[8:11]
    v_add_f32_dpp v16, v14, v16 quad_perm:[2,2,2,2] row_mask:0xf bank_mask:0xf
    ds_read_b128 v[176:179], v7 offset:12288
    s_waitcnt lgkmcnt(5)
    v_mfma_f32_16x16x32_bf16 v[8:11], v[144:147], v[48:51], v[8:11]
    v_add_f32_dpp v17, v15, v17 quad_perm:[3,3,3,3] row_mask:0xf bank_mask:0xf
    s_cmp_gt_i32 s69, 26
    s_cbranch_scc1 L_h_124
    s_waitcnt vmcnt(4)
L_h_124:
    s_waitcnt vmcnt(6)
    buffer_load_dwordx4 v[104:107], v3, s[36:39], s48 offen offset:0 nt
    ds_read_b128 v[180:183], v7 offset:13312
    v_mfma_f32_16x16x32_bf16 v[8:11], v[148:151], v[52:55], v[8:11]
    v_add_f32 v16, v16, v17
    ds_read_b128 v[184:187], v7 offset:14336
    v_mfma_f32_16x16x32_bf16 v[8:11], v[152:155], v[56:59], v[8:11]
    ds_write_b32 v5, v16 offset:272
    ds_read_b128 v[188:191], v7 offset:15360
    v_mfma_f32_16x16x32_bf16 v[8:11], v[156:159], v[60:63], v[8:11]
    ds_read_b128 v[192:195], v7 offset:16384
    s_waitcnt lgkmcnt(5)
    v_mfma_f32_16x16x32_bf16 v[12:15], v[160:163], v[32:35], 0
    ds_read_b128 v[196:199], v7 offset:17408
    v_mfma_f32_16x16x32_bf16 v[12:15], v[164:167], v[36:39], v[12:15]
    s_nop 2
    v_mov_b32_dpp v16, v8 quad_perm:[0,0,0,0] row_mask:0xf bank_mask:0xf
    ds_read_b128 v[200:203], v7 offset:18432
    v_mfma_f32_16x16x32_bf16 v[12:15], v[168:171], v[40:43], v[12:15]
    v_mov_b32_dpp v17, v9 quad_perm:[1,1,1,1] row_mask:0xf bank_mask:0xf
    ds_read_b128 v[204:207], v7 offset:19456
    v_mfma_f32_16x16x32_bf16 v[12:15], v[172:175], v[44:47], v[12:15]
    v_add_f32_dpp v16, v10, v16 quad_perm:[2,2,2,2] row_mask:0xf bank_mask:0xf
    ds_read_b128 v[208:211], v7 offset:20480
    s_waitcnt lgkmcnt(5)
    v_mfma_f32_16x16x32_bf16 v[12:15], v[176:179], v[48:51], v[12:15]
    v_add_f32_dpp v17, v11, v17 quad_perm:[3,3,3,3] row_mask:0xf bank_mask:0xf
    s_cmp_gt_i32 s69, 27
    s_cbranch_scc1 L_h_126
    s_waitcnt vmcnt(4)
L_h_126:
    s_waitcnt vmcnt(5)
    buffer_load_dwordx4 v[108:111], v3, s[36:39], s48 offen offset:256 nt
    s_xor_b32 s48, s48, s13
    ds_read_b128 v[212:215], v7 offset:21504
    v_mfma_f32_16x16x32_bf16 v[12:15], v[180:183], v[52:55], v[12:15]
    v_add_f32 v16, v16, v17
    ds_read_b128 v[216:219], v7 offset:22528
    v_mfma_f32_16x16x32_bf16 v[12:15], v[184:187], v[56:59], v[12:15]
    ds_write_b32 v5, v16 offset:288
    ds_read_b128 v[220:223], v7 offset:23552
    v_mfma_f32_16x16x32_bf16 v[12:15], v[188:191], v[60:63], v[12:15]
    ds_read_b128 v[224:227], v7 offset:24576
    s_waitcnt lgkmcnt(5)
    v_mfma_f32_16x16x32_bf16 v[8:11], v[192:195], v[32:35], 0
    ds_read_b128 v[228:231], v7 offset:25600
    v_mfma_f32_16x16x32_bf16 v[8:11], v[196:199], v[36:39], v[8:11]
    s_nop 2
    v_mov_b32_dpp v16, v12 quad_perm:[0,0,0,0] row_mask:0xf bank_mask:0xf
    ds_read_b128 v[232:235], v7 offset:26624
    v_mfma_f32_16x16x32_bf16 v[8:11], v[200:203], v[40:43], v[8:11]
    v_mov_b32_dpp v17, v13 quad_perm:[1,1,1,1] row_mask:0xf bank_mask:0xf
    ds_read_b128 v[236:239], v7 offset:27648
    v_mfma_f32_16x16x32_bf16 v[8:11], v[204:207], v[44:47], v[8:11]
    v_add_f32_dpp v16, v14, v16 quad_perm:[2,2,2,2] row_mask:0xf bank_mask:0xf
    ds_read_b128 v[240:243], v7 offset:28672
    s_waitcnt lgkmcnt(5)
    v_mfma_f32_16x16x32_bf16 v[8:11], v[208:211], v[48:51], v[8:11]
    v_add_f32_dpp v17, v15, v17 quad_perm:[3,3,3,3] row_mask:0xf bank_mask:0xf
    s_cmp_gt_i32 s69, 28
    s_cbranch_scc1 L_h_128
    s_waitcnt vmcnt(4)
L_h_128:
    s_waitcnt vmcnt(5)
    buffer_load_dwordx4 v[112:115], v3, s[36:39], s48 offen offset:0 nt
    s_cmp_eq_u32 s66, 0
    s_cbranch_scc1 L_nofb_130
    v_lshl_add_u32 v1, v0, 13, v1
    v_and_b32 v1, 0xffff, v1
    v_subrev_u32 v2, s68, v2
    v_cmp_gt_u32 s[22:23], 64, v2
    s_and_b32 s20, s22, 0x7f
    s_bcnt1_i32_b32 s20, s20
    s_cmp_lt_u32 s72, 2
    s_cselect_b64 s[26:27], s[6:7], s[4:5]
    s_lshl_b32 s20, s20, 3
    s_lshr_b64 s[26:27], s[26:27], s20
    s_sext_i32_i8 s26, s26
    v_mov_b32 v2, 16896
    v_mov_b32 v4, s26
    ds_write_b32 v2, v4 offset:16
L_nofb_130:
    s_add_u32 s68, s68, 1
    s_lshr_b32 s72, s72, 1
    s_bitcmp1_b32 s72, 0
    s_cselect_b32 s66, s71, 0
    s_branch L_brk1_131s
.p2align 12
L_brk1_131:
    s_setpc_b64 s[4:5]
L_brk1_131s:
    ds_read_b128 v[244:247], v7 offset:29696
    v_mfma_f32_16x16x32_bf16 v[8:11], v[212:215], v[52:55], v[8:11]
    v_add_f32 v16, v16, v17
    ds_read_b128 v[248:251], v7 offset:30720
    v_mfma_f32_16x16x32_bf16 v[8:11], v[216:219], v[56:59], v[8:11]
    ds_write_b32 v5, v16 offset:304
    ds_read_b128 v[252:255], v7 offset:31744
    v_mfma_f32_16x16x32_bf16 v[8:11], v[220:223], v[60:63], v[8:11]
    s_waitcnt lgkmcnt(0)
    v_mfma_f32_16x16x32_bf16 v[12:15], v[224:227], v[32:35], 0
    v_mfma_f32_16x16x32_bf16 v[12:15], v[228:231], v[36:39], v[12:15]
    s_nop 4
    v_mov_b32_dpp v16, v8 quad_perm:[0,0,0,0] row_mask:0xf bank_mask:0xf
    v_mfma_f32_16x16x32_bf16 v[12:15], v[232:235], v[40:43], v[12:15]
    v_mov_b32_dpp v17, v9 quad_perm:[1,1,1,1] row_mask:0xf bank_mask:0xf
    v_mfma_f32_16x16x32_bf16 v[12:15], v[236:239], v[44:47], v[12:15]
    v_add_f32_dpp v16, v10, v16 quad_perm:[2,2,2,2] row_mask:0xf bank_mask:0xf
    s_waitcnt lgkmcnt(0)
    v_mfma_f32_16x16x32_bf16 v[12:15], v[240:243], v[48:51], v[12:15]
    v_add_f32_dpp v17, v11, v17 quad_perm:[3,3,3,3] row_mask:0xf bank_mask:0xf
    s_cmp_gt_i32 s69, 29
    s_cbranch_scc1 L_h_132
    s_waitcnt vmcnt(4)
L_h_132:
    s_waitcnt vmcnt(5)
    buffer_load_dwordx4 v[116:119], v3, s[36:39], s48 offen offset:256 nt
    s_xor_b32 s48, s48, s12
    v_mfma_f32_16x16x32_bf16 v[12:15], v[244:247], v[52:55], v[12:15]
    v_add_f32 v16, v16, v17
    v_mfma_f32_16x16x32_bf16 v[12:15], v[248:251], v[56:59], v[12:15]
    ds_write_b32 v5, v16 offset:512
    v_mfma_f32_16x16x32_bf16 v[12:15], v[252:255], v[60:63], v[12:15]
    v_mfma_f32_16x16x32_bf16 v[8:11], v[64:67], v[32:35], 0
    v_mfma_f32_16x16x32_bf16 v[8:11], v[68:71], v[36:39], v[8:11]
    s_nop 5
    v_mov_b32_dpp v16, v12 quad_perm:[0,0,0,0] row_mask:0xf bank_mask:0xf
    v_mfma_f32_16x16x32_bf16 v[8:11], v[72:75], v[40:43], v[8:11]
    v_mov_b32_dpp v17, v13 quad_perm:[1,1,1,1] row_mask:0xf bank_mask:0xf
    v_mfma_f32_16x16x32_bf16 v[8:11], v[76:79], v[44:47], v[8:11]
    v_add_f32_dpp v16, v14, v16 quad_perm:[2,2,2,2] row_mask:0xf bank_mask:0xf
    v_mfma_f32_16x16x32_bf16 v[8:11], v[80:83], v[48:51], v[8:11]
    v_add_f32_dpp v17, v15, v17 quad_perm:[3,3,3,3] row_mask:0xf bank_mask:0xf
    s_cmp_gt_i32 s69, 30
    s_cbranch_scc1 L_h_134
    s_waitcnt vmcnt(4)
L_h_134:
    s_waitcnt vmcnt(5)
    buffer_load_dwordx4 v[120:123], v3, s[36:39], s48 offen offset:0 nt
    v_mov_b32 v4, 16896
    v_mov_b32 v2, 1
    s_mov_b64 exec, 1
    ds_add_rtn_u32 v2, v4, v2 offset:20
    s_mov_b64 exec, -1
    ds_read_b32 v4, v4 offset:16
    v_mfma_f32_16x16x32_bf16 v[8:11], v[84:87], v[52:55], v[8:11]
    v_add_f32 v16, v16, v17
    v_mfma_f32_16x16x32_bf16 v[8:11], v[88:91], v[56:59], v[8:11]
    ds_write_b32 v5, v16 offset:528
    s_cmp_gt_i32 s69, 31
    s_cbranch_scc1 L_h_136
    s_waitcnt vmcnt(4)
L_h_136:
    s_waitcnt vmcnt(5)
    buffer_load_dwordx4 v[124:127], v3, s[36:39], s48 offen offset:256 nt
    s_xor_b32 s48, s48, s16
    s_waitcnt lgkmcnt(0)
    v_readfirstlane_b32 s69, v4
    v_readfirstlane_b32 s20, v2
    s_lshl_b32 s20, s20, 3
    s_lshr_b32 s20, s73, s20
    s_sext_i32_i8 s20, s20
    s_add_i32 s69, s69, s20
    s_sub_i32 s70, 0, s69
    v_mfma_f32_16x16x32_bf16 v[8:11], v[92:95], v[60:63], v[8:11]
    s_cmp_gt_i32 s69, 0
    s_cbranch_scc1 L_h_138
    s_cmp_gt_i32 s70, 0
    s_cbranch_scc0 L_m_139
    s_waitcnt vmcnt(3)
L_m_139:
    s_waitcnt vmcnt(4)
L_h_138:
    s_waitcnt vmcnt(5)
    buffer_load_dwordx4 v[64:67], v3, s[36:39], s48 offen offset:0 nt
    v_mfma_f32_16x16x32_bf16 v[12:15], v[96:99], v[32:35], 0
    s_cmp_gt_i32 s69, 1
    s_cbranch_scc1 L_h_140
    s_cmp_gt_i32 s70, 1
    s_cbranch_scc0 L_m_141
    s_waitcnt vmcnt(3)
L_m_141:
    s_waitcnt vmcnt(4)
L_h_140:
    s_waitcnt vmcnt(5)
    buffer_load_dwordx4 v[68:71], v3, s[36:39], s48 offen offset:256 nt
    s_xor_b32 s48, s48, s12
    v_mfma_f32_16x16x32_bf16 v[12:15], v[100:103], v[36:39], v[12:15]
    v_mov_b32_dpp v16, v8 quad_perm:[0,0,0,0] row_mask:0xf bank_mask:0xf
    s_cmp_gt_i32 s69, 2
    s_cbranch_scc1 L_h_142
    s_cmp_gt_i32 s70, 2
    s_cbranch_scc0 L_m_143
    s_waitcnt vmcnt(3)
L_m_143:
    s_waitcnt vmcnt(4)
L_h_142:
    s_waitcnt vmcnt(5)
    buffer_load_dwordx4 v[72:75], v3, s[36:39], s48 offen offset:0 nt
    v_mfma_f32_16x16x32_bf16 v[12:15], v[104:107], v[40:43], v[12:15]
    v_mov_b32_dpp v17, v9 quad_perm:[1,1,1,1] row_mask:0xf bank_mask:0xf
    s_cmp_gt_i32 s69, 3
    s_cbranch_scc1 L_h_144
    s_cmp_gt_i32 s70, 3
    s_cbranch_scc0 L_m_145
    s_waitcnt vmcnt(3)
L_m_145:
    s_waitcnt vmcnt(4)
L_h_144:
    s_waitcnt vmcnt(5)
    buffer_load_dwordx4 v[76:79], v3, s[36:39], s48 offen offset:256 nt
    s_xor_b32 s48, s48, s13
    v_mfma_f32_16x16x32_bf16 v[12:15], v[108:111], v[44:47], v[12:15]
    v_add_f32_dpp v16, v10, v16 quad_perm:[2,2,2,2] row_mask:0xf bank_mask:0xf
    s_cmp_gt_i32 s69, 4
    s_cbranch_scc1 L_h_146
    s_cmp_gt_i32 s70, 4
    s_cbranch_scc0 L_m_147
    s_waitcnt vmcnt(3)
L_m_147:
    s_waitcnt vmcnt(4)
L_h_146:
    s_waitcnt vmcnt(5)
    buffer_load_dwordx4 v[80:83], v3, s[36:39], s48 offen offset:0 nt
    v_mfma_f32_16x16x32_bf16 v[12:15], v[112:115], v[48:51], v[12:15]
    v_add_f32_dpp v17, v11, v17 quad_perm:[3,3,3,3] row_mask:0xf bank_mask:0xf
    s_cmp_gt_i32 s69, 5
    s_cbranch_scc1 L_h_148
    s_cmp_gt_i32 s70, 5
    s_cbranch_scc0 L_m_149
    s_waitcnt vmcnt(3)
L_m_149:
    s_waitcnt vmcnt(4)
L_h_148:
    s_waitcnt vmcnt(5)
    buffer_load_dwordx4 v[84:87], v3, s[36:39], s48 offen offset:256 nt
    s_xor_b32 s48, s48, s12
    v_mfma_f32_16x16x32_bf16 v[12:15], v[116:119], v[52:55], v[12:15]
    v_add_f32 v16, v16, v17
    s_cmp_gt_i32 s69, 6
    s_cbranch_scc1 L_h_150
    s_cmp_gt_i32 s70, 6
    s_cbranch_scc0 L_m_151
    s_waitcnt vmcnt(3)
L_m_151:
    s_waitcnt vmcnt(4)
L_h_150:
    s_waitcnt vmcnt(5)
    buffer_load_dwordx4 v[88:91], v3, s[36:39], s48 offen offset:0 nt
    v_mfma_f32_16x16x32_bf16 v[12:15], v[120:123], v[56:59], v[12:15]
    ds_write_b32 v5, v16 offset:544
    s_cmp_gt_i32 s69, 7
    s_cbranch_scc1 L_h_152
    s_cmp_gt_i32 s70, 7
    s_cbranch_scc0 L_m_153
    s_waitcnt vmcnt(3)
L_m_153:
    s_waitcnt vmcnt(4)
L_h_152:
    s_waitcnt vmcnt(5)
    buffer_load_dwordx4 v[92:95], v3, s[36:39], s48 offen offset:256 nt
    s_xor_b32 s48, s48, s14
    v_mfma_f32_16x16x32_bf16 v[12:15], v[124:127], v[60:63], v[12:15]
    s_mov_b32 s49, 12
    s_mov_b32 s60, 4
    s_branch L_brk2_155s
L_brk2_155:
    s_setpc_b64 s[4:5]
L_brk2_155s:
L_st_154:
    s_cmp_gt_i32 s69, 8
    s_cbranch_scc1 L_h_156
    s_cmp_gt_i32 s70, 8
    s_cbranch_scc0 L_m_157
    s_waitcnt vmcnt(3)
L_m_157:
    s_waitcnt vmcnt(4)
L_h_156:
    s_waitcnt vmcnt(5)
    buffer_load_dwordx4 v[96:99], v3, s[36:39], s48 offen offset:0 nt
    v_mfma_f32_16x16x32_bf16 v[8:11], v[64:67], v[32:35], 0
    s_cmp_gt_i32 s69, 9
    s_cbranch_scc1 L_h_158
    s_cmp_gt_i32 s70, 9
    s_cbranch_scc0 L_m_159
    s_waitcnt vmcnt(3)
L_m_159:
    s_waitcnt vmcnt(4)
L_h_158:
    s_waitcnt vmcnt(5)
    buffer_load_dwordx4 v[100:103], v3, s[36:39], s48 offen offset:256 nt
    s_xor_b32 s48, s48, s12
    v_mfma_f32_16x16x32_bf16 v[8:11], v[68:71], v[36:39], v[8:11]
    v_mov_b32_dpp v16, v12 quad_perm:[0,0,0,0] row_mask:0xf bank_mask:0xf
    s_cmp_gt_i32 s69, 10
    s_cbranch_scc1 L_h_160
    s_cmp_gt_i32 s70, 10
    s_cbranch_scc0 L_m_161
    s_waitcnt vmcnt(3)
L_m_161:
    s_waitcnt vmcnt(4)
L_h_160:
    s_waitcnt vmcnt(5)
    buffer_load_dwordx4 v[104:107], v3, s[36:39], s48 offen offset:0 nt
    v_mfma_f32_16x16x32_bf16 v[8:11], v[72:75], v[40:43], v[8:11]
    v_mov_b32_dpp v17, v13 quad_perm:[1,1,1,1] row_mask:0xf bank_mask:0xf
    s_cmp_gt_i32 s69, 11
    s_cbranch_scc1 L_h_162
    s_cmp_gt_i32 s70, 11
    s_cbranch_scc0 L_m_163
    s_waitcnt vmcnt(3)
L_m_163:
    s_waitcnt vmcnt(4)
L_h_162:
    s_waitcnt vmcnt(5)
    buffer_load_dwordx4 v[108:111], v3, s[36:39], s48 offen offset:256 nt
    s_xor_b32 s48, s48, s13
    v_mfma_f32_16x16x32_bf16 v[8:11], v[76:79], v[44:47], v[8:11]
    v_add_f32_dpp v16, v14, v16 quad_perm:[2,2,2,2] row_mask:0xf bank_mask:0xf
    s_cmp_gt_i32 s69, 12
    s_cbranch_scc1 L_h_164
    s_cmp_gt_i32 s70, 12
    s_cbranch_scc0 L_m_165
    s_waitcnt vmcnt(3)
L_m_165:
    s_waitcnt vmcnt(4)
L_h_164:
    s_waitcnt vmcnt(5)
    buffer_load_dwordx4 v[112:115], v3, s[36:39], s48 offen offset:0 nt
    v_mfma_f32_16x16x32_bf16 v[8:11], v[80:83], v[48:51], v[8:11]
    v_add_f32_dpp v17, v15, v17 quad_perm:[3,3,3,3] row_mask:0xf bank_mask:0xf
    s_cmp_gt_i32 s69, 13
    s_cbranch_scc1 L_h_166
    s_cmp_gt_i32 s70, 13
    s_cbranch_scc0 L_m_167
    s_waitcnt vmcnt(3)
L_m_167:
    s_waitcnt vmcnt(4)
L_h_166:
    s_waitcnt vmcnt(5)
    buffer_load_dwordx4 v[116:119], v3, s[36:39], s48 offen offset:256 nt
    s_xor_b32 s48, s48, s12
    v_mfma_f32_16x16x32_bf16 v[8:11], v[84:87], v[52:55], v[8:11]
    v_add_f32 v16, v16, v17
    s_cmp_gt_i32 s69, 14
    s_cbranch_scc1 L_h_168
    s_cmp_gt_i32 s70, 14
    s_cbranch_scc0 L_m_169
    s_waitcnt vmcnt(3)
L_m_169:
    s_waitcnt vmcnt(4)
L_h_168:
    s_waitcnt vmcnt(5)
    buffer_load_dwordx4 v[120:123], v3, s[36:39], s48 offen offset:0 nt
    v_mfma_f32_16x16x32_bf16 v[8:11], v[88:91], v[56:59], v[8:11]
    ds_write_b32 v5, v16 offset:560
    s_cmp_gt_i32 s69, 15
    s_cbranch_scc1 L_h_170
    s_cmp_gt_i32 s70, 15
    s_cbranch_scc0 L_m_171
    s_waitcnt vmcnt(3)
L_m_171:
    s_waitcnt vmcnt(4)
L_h_170:
    s_waitcnt vmcnt(5)
    buffer_load_dwordx4 v[124:127], v3, s[36:39], s48 offen offset:256 nt
    s_xor_b32 s48, s48, s15
    v_mfma_f32_16x16x32_bf16 v[8:11], v[92:95], v[60:63], v[8:11]
    s_cmp_gt_i32 s69, 16
    s_cbranch_scc1 L_h_172
    s_waitcnt vmcnt(4)
L_h_172:
    s_waitcnt vmcnt(5)
    buffer_load_dwordx4 v[64:67], v3, s[36:39], s48 offen offset:0 nt
    v_mfma_f32_16x16x32_bf16 v[12:15], v[96:99], v[32:35], 0
    s_cmp_gt_i32 s69, 17
    s_cbranch_scc1 L_h_174
    s_waitcnt vmcnt(4)
L_h_174:
    s_waitcnt vmcnt(5)
    buffer_load_dwordx4 v[68:71], v3, s[36:39], s48 offen offset:256 nt
    s_xor_b32 s48, s48, s12
    v_mfma_f32_16x16x32_bf16 v[12:15], v[100:103], v[36:39], v[12:15]
    v_mov_b32_dpp v16, v8 quad_perm:[0,0,0,0] row_mask:0xf bank_mask:0xf
    s_cmp_gt_i32 s69, 18
    s_cbranch_scc1 L_h_176
    s_waitcnt vmcnt(4)
L_h_176:
    s_waitcnt vmcnt(5)
    buffer_load_dwordx4 v[72:75], v3, s[36:39], s48 offen offset:0 nt
    v_mfma_f32_16x16x32_bf16 v[12:15], v[104:107], v[40:43], v[12:15]
    v_mov_b32_dpp v17, v9 quad_perm:[1,1,1,1] row_mask:0xf bank_mask:0xf
    s_cmp_gt_i32 s69, 19
    s_cbranch_scc1 L_h_178
    s_waitcnt vmcnt(4)
L_h_178:
    s_waitcnt vmcnt(5)
    buffer_load_dwordx4 v[76:79], v3, s[36:39], s48 offen offset:256 nt
    s_xor_b32 s48, s48, s13
    v_mov_b32 v4, s68
    s_mov_b64 exec, 1
    buffer_store_dword v4, off, s[64:67], s63 sc1
    s_mov_b64 exec, -1
    v_mfma_f32_16x16x32_bf16 v[12:15], v[108:111], v[44:47], v[12:15]
    v_add_f32_dpp v16, v10, v16 quad_perm:[2,2,2,2] row_mask:0xf bank_mask:0xf
    s_cmp_gt_i32 s69, 20
    s_cbranch_scc1 L_h_180
    s_waitcnt vmcnt(5)
L_h_180:
    s_waitcnt vmcnt(6)
    buffer_load_dwordx4 v[80:83], v3, s[36:39], s48 offen offset:0 nt
    s_mov_b64 exec, 0x7f
    buffer_load_dword v2, v1, s[64:67], 0 offen sc1
    s_mov_b64 exec, -1
    v_mfma_f32_16x16x32_bf16 v[12:15], v[112:115], v[48:51], v[12:15]
    v_add_f32_dpp v17, v11, v17 quad_perm:[3,3,3,3] row_mask:0xf bank_mask:0xf
    s_cmp_gt_i32 s69, 21
    s_cbranch_scc1 L_h_182
    s_waitcnt vmcnt(6)
L_h_182:
    s_waitcnt vmcnt(7)
    buffer_load_dwordx4 v[84:87], v3, s[36:39], s48 offen offset:256 nt
    s_xor_b32 s48, s48, s12
    v_mfma_f32_16x16x32_bf16 v[12:15], v[116:119], v[52:55], v[12:15]
    v_add_f32 v16, v16, v17
    s_cmp_gt_i32 s69, 22
    s_cbranch_scc1 L_h_184
    s_waitcnt vmcnt(6)
L_h_184:
    s_waitcnt vmcnt(7)
    buffer_load_dwordx4 v[88:91], v3, s[36:39], s48 offen offset:0 nt
    v_mfma_f32_16x16x32_bf16 v[12:15], v[120:123], v[56:59], v[12:15]
    ds_write_b32 v5, v16 offset:768
    s_cmp_gt_i32 s69, 23
    s_cbranch_scc1 L_h_186
    s_waitcnt vmcnt(6)
L_h_186:
    s_waitcnt vmcnt(7)
    buffer_load_dwordx4 v[92:95], v3, s[36:39], s48 offen offset:256 nt
    s_xor_b32 s48, s48, s14
    v_mfma_f32_16x16x32_bf16 v[12:15], v[124:127], v[60:63], v[12:15]
    s_cmp_gt_i32 s69, 24
    s_cbranch_scc1 L_h_188
    s_waitcnt vmcnt(6)
L_h_188:
    s_waitcnt vmcnt(7)
    buffer_load_dwordx4 v[96:99], v3, s[36:39], s48 offen offset:0 nt
    v_mfma_f32_16x16x32_bf16 v[8:11], v[64:67], v[32:35], 0
    s_cmp_gt_i32 s69, 25
    s_cbranch_scc1 L_h_190
    s_waitcnt vmcnt(5)
L_h_190:
    s_waitcnt vmcnt(7)
    buffer_load_dwordx4 v[100:103], v3, s[36:39], s48 offen offset:256 nt
    s_xor_b32 s48, s48, s12
    v_mfma_f32_16x16x32_bf16 v[8:11], v[68:71], v[36:39], v[8:11]
    v_mov_b32_dpp v16, v12 quad_perm:[0,0,0,0] row_mask:0xf bank_mask:0xf
    s_cmp_gt_i32 s69, 26
    s_cbranch_scc1 L_h_192
    s_waitcnt vmcnt(4)
L_h_192:
    s_waitcnt vmcnt(6)
    buffer_load_dwordx4 v[104:107], v3, s[36:39], s48 offen offset:0 nt
    v_mfma_f32_16x16x32_bf16 v[8:11], v[72:75], v[40:43], v[8:11]
    v_mov_b32_dpp v17, v13 quad_perm:[1,1,1,1] row_mask:0xf bank_mask:0xf
    s_cmp_gt_i32 s69, 27
    s_cbranch_scc1 L_h_194
    s_waitcnt vmcnt(4)
L_h_194:
    s_waitcnt vmcnt(5)
    buffer_load_dwordx4 v[108:111], v3, s[36:39], s48 offen offset:256 nt
    s_xor_b32 s48, s48, s13
    v_mfma_f32_16x16x32_bf16 v[8:11], v[76:79], v[44:47], v[8:11]
    v_add_f32_dpp v16, v14, v16 quad_perm:[2,2,2,2] row_mask:0xf bank_mask:0xf
    s_cmp_gt_i32 s69, 28
    s_cbranch_scc1 L_h_196
    s_waitcnt vmcnt(4)
L_h_196:
    s_waitcnt vmcnt(5)
    buffer_load_dwordx4 v[112:115], v3, s[36:39], s48 offen offset:0 nt
    s_cmp_eq_u32 s66, 0
    s_cbranch_scc1 L_nofb_198
    v_lshl_add_u32 v1, v0, 13, v1
    v_and_b32 v1, 0xffff, v1
    v_subrev_u32 v2, s68, v2
    v_cmp_gt_u32 s[22:23], 64, v2
    s_and_b32 s20, s22, 0x7f
    s_bcnt1_i32_b32 s20, s20
    s_cmp_lt_u32 s72, 2
    s_cselect_b64 s[26:27], s[6:7], s[4:5]
    s_lshl_b32 s20, s20, 3
    s_lshr_b64 s[26:27], s[26:27], s20
    s_sext_i32_i8 s26, s26
    v_mov_b32 v2, 16896
    v_mov_b32 v4, s26
    ds_write_b32 v2, v4 offset:16
L_nofb_198:
    s_add_u32 s68, s68, 1
    s_lshr_b32 s72, s72, 1
    s_bitcmp1_b32 s72, 0
    s_cselect_b32 s66, s71, 0
    v_mfma_f32_16x16x32_bf16 v[8:11], v[80:83], v[48:51], v[8:11]
    v_add_f32_dpp v17, v15, v17 quad_perm:[3,3,3,3] row_mask:0xf bank_mask:0xf
    s_cmp_gt_i32 s69, 29
    s_cbranch_scc1 L_h_199
    s_waitcnt vmcnt(4)
L_h_199:
    s_waitcnt vmcnt(5)
    buffer_load_dwordx4 v[116:119], v3, s[36:39], s48 offen offset:256 nt
    s_xor_b32 s48, s48, s12
    v_mfma_f32_16x16x32_bf16 v[8:11], v[84:87], v[52:55], v[8:11]
    v_add_f32 v16, v16, v17
    s_cmp_gt_i32 s69, 30
    s_cbranch_scc1 L_h_201
    s_waitcnt vmcnt(4)
L_h_201:
    s_waitcnt vmcnt(5)
    buffer_load_dwordx4 v[120:123], v3, s[36:39], s48 offen offset:0 nt
    v_mov_b32 v4, 16896
    v_mov_b32 v2, 1
    s_mov_b64 exec, 1
    ds_add_rtn_u32 v2, v4, v2 offset:20
    s_mov_b64 exec, -1
    ds_read_b32 v4, v4 offset:16
    v_mfma_f32_16x16x32_bf16 v[8:11], v[88:91], v[56:59], v[8:11]
    ds_write_b32 v5, v16 offset:784
    s_cmp_gt_i32 s69, 31
    s_cbranch_scc1 L_h_203
    s_waitcnt vmcnt(4)
L_h_203:
    s_waitcnt vmcnt(5)
    buffer_load_dwordx4 v[124:127], v3, s[36:39], s48 offen offset:256 nt
    s_ff1_i32_b32 s20, s60
    s_add_u32 s60, s60, 1
    s_cmp_eq_u32 s20, 2
    s_cselect_b32 s21, s18, s19
    s_cmp_eq_u32 s20, 1
    s_cselect_b32 s21, s17, s21
    s_cmp_eq_u32 s20, 0
    s_cselect_b32 s21, s16, s21
    s_xor_b32 s48, s48, s21
    s_waitcnt lgkmcnt(0)
    v_readfirstlane_b32 s69, v4
    v_readfirstlane_b32 s20, v2
    s_lshl_b32 s20, s20, 3
    s_lshr_b32 s20, s73, s20
    s_sext_i32_i8 s20, s20
    s_add_i32 s69, s69, s20
    s_sub_i32 s70, 0, s69
    v_mfma_f32_16x16x32_bf16 v[8:11], v[92:95], v[60:63], v[8:11]
    s_cmp_gt_i32 s69, 0
    s_cbranch_scc1 L_h_205
    s_cmp_gt_i32 s70, 0
    s_cbranch_scc0 L_m_206
    s_waitcnt vmcnt(3)
L_m_206:
    s_waitcnt vmcnt(4)
L_h_205:
    s_waitcnt vmcnt(5)
    buffer_load_dwordx4 v[64:67], v3, s[36:39], s48 offen offset:0 nt
    v_mfma_f32_16x16x32_bf16 v[12:15], v[96:99], v[32:35], 0
    s_cmp_gt_i32 s69, 1
    s_cbranch_scc1 L_h_207
    s_cmp_gt_i32 s70, 1
    s_cbranch_scc0 L_m_208
    s_waitcnt vmcnt(3)
L_m_208:
    s_waitcnt vmcnt(4)
L_h_207:
    s_waitcnt vmcnt(5)
    buffer_load_dwordx4 v[68:71], v3, s[36:39], s48 offen offset:256 nt
    s_xor_b32 s48, s48, s12
    v_mfma_f32_16x16x32_bf16 v[12:15], v[100:103], v[36:39], v[12:15]
    v_mov_b32_dpp v16, v8 quad_perm:[0,0,0,0] row_mask:0xf bank_mask:0xf
    s_cmp_gt_i32 s69, 2
    s_cbranch_scc1 L_h_209
    s_cmp_gt_i32 s70, 2
    s_cbranch_scc0 L_m_210
    s_waitcnt vmcnt(3)
L_m_210:
    s_waitcnt vmcnt(4)
L_h_209:
    s_waitcnt vmcnt(5)
    buffer_load_dwordx4 v[72:75], v3, s[36:39], s48 offen offset:0 nt
    v_mfma_f32_16x16x32_bf16 v[12:15], v[104:107], v[40:43], v[12:15]
    v_mov_b32_dpp v17, v9 quad_perm:[1,1,1,1] row_mask:0xf bank_mask:0xf
    s_cmp_gt_i32 s69, 3
    s_cbranch_scc1 L_h_211
    s_cmp_gt_i32 s70, 3
    s_cbranch_scc0 L_m_212
    s_waitcnt vmcnt(3)
L_m_212:
    s_waitcnt vmcnt(4)
L_h_211:
    s_waitcnt vmcnt(5)
    buffer_load_dwordx4 v[76:79], v3, s[36:39], s48 offen offset:256 nt
    s_xor_b32 s48, s48, s13
    v_mfma_f32_16x16x32_bf16 v[12:15], v[108:111], v[44:47], v[12:15]
    v_add_f32_dpp v16, v10, v16 quad_perm:[2,2,2,2] row_mask:0xf bank_mask:0xf
    s_cmp_gt_i32 s69, 4
    s_cbranch_scc1 L_h_213
    s_cmp_gt_i32 s70, 4
    s_cbranch_scc0 L_m_214
    s_waitcnt vmcnt(3)
L_m_214:
    s_waitcnt vmcnt(4)
L_h_213:
    s_waitcnt vmcnt(5)
    buffer_load_dwordx4 v[80:83], v3, s[36:39], s48 offen offset:0 nt
    v_mfma_f32_16x16x32_bf16 v[12:15], v[112:115], v[48:51], v[12:15]
    v_add_f32_dpp v17, v11, v17 quad_perm:[3,3,3,3] row_mask:0xf bank_mask:0xf
    s_cmp_gt_i32 s69, 5
    s_cbranch_scc1 L_h_215
    s_cmp_gt_i32 s70, 5
    s_cbranch_scc0 L_m_216
    s_waitcnt vmcnt(3)
L_m_216:
    s_waitcnt vmcnt(4)
L_h_215:
    s_waitcnt vmcnt(5)
    buffer_load_dwordx4 v[84:87], v3, s[36:39], s48 offen offset:256 nt
    s_xor_b32 s48, s48, s12
    v_mfma_f32_16x16x32_bf16 v[12:15], v[116:119], v[52:55], v[12:15]
    v_add_f32 v16, v16, v17
    s_cmp_gt_i32 s69, 6
    s_cbranch_scc1 L_h_217
    s_cmp_gt_i32 s70, 6
    s_cbranch_scc0 L_m_218
    s_waitcnt vmcnt(3)
L_m_218:
    s_waitcnt vmcnt(4)
L_h_217:
    s_waitcnt vmcnt(5)
    buffer_load_dwordx4 v[88:91], v3, s[36:39], s48 offen offset:0 nt
    v_mfma_f32_16x16x32_bf16 v[12:15], v[120:123], v[56:59], v[12:15]
    ds_write_b32 v5, v16 offset:800
    s_cmp_gt_i32 s69, 7
    s_cbranch_scc1 L_h_219
    s_cmp_gt_i32 s70, 7
    s_cbranch_scc0 L_m_220
    s_waitcnt vmcnt(3)
L_m_220:
    s_waitcnt vmcnt(4)
L_h_219:
    s_waitcnt vmcnt(5)
    buffer_load_dwordx4 v[92:95], v3, s[36:39], s48 offen offset:256 nt
    s_xor_b32 s48, s48, s14
    v_mfma_f32_16x16x32_bf16 v[12:15], v[124:127], v[60:63], v[12:15]
    v_add_u32 v5, 0x100, v5
    s_sub_u32 s49, s49, 1
    s_cmp_lg_u32 s49, 0
    s_cbranch_scc1 L_st_154
    s_branch L_brk2_221s
.p2align 12
L_brk2_221:
    s_setpc_b64 s[4:5]
L_brk2_221s:
    s_cmp_gt_i32 s69, 8
    s_cbranch_scc1 L_h_222
    s_cmp_gt_i32 s70, 8
    s_cbranch_scc0 L_m_223
    s_waitcnt vmcnt(3)
L_m_223:
    s_waitcnt vmcnt(4)
L_h_222:
    s_waitcnt vmcnt(5)
    buffer_load_dwordx4 v[96:99], v3, s[36:39], s48 offen offset:0 nt
    v_mfma_f32_16x16x32_bf16 v[8:11], v[64:67], v[32:35], 0
    s_cmp_gt_i32 s69, 9
    s_cbranch_scc1 L_h_224
    s_cmp_gt_i32 s70, 9
    s_cbranch_scc0 L_m_225
    s_waitcnt vmcnt(3)
L_m_225:
    s_waitcnt vmcnt(4)
L_h_224:
    s_waitcnt vmcnt(5)
    buffer_load_dwordx4 v[100:103], v3, s[36:39], s48 offen offset:256 nt
    s_xor_b32 s48, s48, s12
    v_mfma_f32_16x16x32_bf16 v[8:11], v[68:71], v[36:39], v[8:11]
    v_mov_b32_dpp v16, v12 quad_perm:[0,0,0,0] row_mask:0xf bank_mask:0xf
    s_cmp_gt_i32 s69, 10
    s_cbranch_scc1 L_h_226
    s_cmp_gt_i32 s70, 10
    s_cbranch_scc0 L_m_227
    s_waitcnt vmcnt(3)
L_m_227:
    s_waitcnt vmcnt(4)
L_h_226:
    s_waitcnt vmcnt(5)
    buffer_load_dwordx4 v[104:107], v3, s[36:39], s48 offen offset:0 nt
    v_mfma_f32_16x16x32_bf16 v[8:11], v[72:75], v[40:43], v[8:11]
    v_mov_b32_dpp v17, v13 quad_perm:[1,1,1,1] row_mask:0xf bank_mask:0xf
    s_cmp_gt_i32 s69, 11
    s_cbranch_scc1 L_h_228
    s_cmp_gt_i32 s70, 11
    s_cbranch_scc0 L_m_229
    s_waitcnt vmcnt(3)
L_m_229:
    s_waitcnt vmcnt(4)
L_h_228:
    s_waitcnt vmcnt(5)
    buffer_load_dwordx4 v[108:111], v3, s[36:39], s48 offen offset:256 nt
    s_xor_b32 s48, s48, s13
    v_mfma_f32_16x16x32_bf16 v[8:11], v[76:79], v[44:47], v[8:11]
    v_add_f32_dpp v16, v14, v16 quad_perm:[2,2,2,2] row_mask:0xf bank_mask:0xf
    s_cmp_gt_i32 s69, 12
    s_cbranch_scc1 L_h_230
    s_cmp_gt_i32 s70, 12
    s_cbranch_scc0 L_m_231
    s_waitcnt vmcnt(3)
L_m_231:
    s_waitcnt vmcnt(4)
L_h_230:
    s_waitcnt vmcnt(5)
    buffer_load_dwordx4 v[112:115], v3, s[36:39], s48 offen offset:0 nt
    v_mfma_f32_16x16x32_bf16 v[8:11], v[80:83], v[48:51], v[8:11]
    v_add_f32_dpp v17, v15, v17 quad_perm:[3,3,3,3] row_mask:0xf bank_mask:0xf
    s_cmp_gt_i32 s69, 13
    s_cbranch_scc1 L_h_232
    s_cmp_gt_i32 s70, 13
    s_cbranch_scc0 L_m_233
    s_waitcnt vmcnt(3)
L_m_233:
    s_waitcnt vmcnt(4)
L_h_232:
    s_waitcnt vmcnt(5)
    buffer_load_dwordx4 v[116:119], v3, s[36:39], s48 offen offset:256 nt
    s_xor_b32 s48, s48, s12
    v_mfma_f32_16x16x32_bf16 v[8:11], v[84:87], v[52:55], v[8:11]
    v_add_f32 v16, v16, v17
    s_cmp_gt_i32 s69, 14
    s_cbranch_scc1 L_h_234
    s_cmp_gt_i32 s70, 14
    s_cbranch_scc0 L_m_235
    s_waitcnt vmcnt(3)
L_m_235:
    s_waitcnt vmcnt(4)
L_h_234:
    s_waitcnt vmcnt(5)
    buffer_load_dwordx4 v[120:123], v3, s[36:39], s48 offen offset:0 nt
    v_mfma_f32_16x16x32_bf16 v[8:11], v[88:91], v[56:59], v[8:11]
    ds_write_b32 v5, v16 offset:560
    s_cmp_gt_i32 s69, 15
    s_cbranch_scc1 L_h_236
    s_cmp_gt_i32 s70, 15
    s_cbranch_scc0 L_m_237
    s_waitcnt vmcnt(3)
L_m_237:
    s_waitcnt vmcnt(4)
L_h_236:
    s_waitcnt vmcnt(5)
    buffer_load_dwordx4 v[124:127], v3, s[36:39], s48 offen offset:256 nt
    s_xor_b32 s48, s48, s15
    v_mfma_f32_16x16x32_bf16 v[8:11], v[92:95], v[60:63], v[8:11]
    s_cmp_gt_i32 s69, 16
    s_cbranch_scc1 L_h_238
    s_waitcnt vmcnt(4)
L_h_238:
    s_waitcnt vmcnt(5)
    buffer_load_dwordx4 v[64:67], v3, s[36:39], s48 offen offset:0 nt
    v_mfma_f32_16x16x32_bf16 v[12:15], v[96:99], v[32:35], 0
    s_cmp_gt_i32 s69, 17
    s_cbranch_scc1 L_h_240
    s_waitcnt vmcnt(4)
L_h_240:
    s_waitcnt vmcnt(5)
    buffer_load_dwordx4 v[68:71], v3, s[36:39], s48 offen offset:256 nt
    s_xor_b32 s48, s48, s12
    v_mfma_f32_16x16x32_bf16 v[12:15], v[100:103], v[36:39], v[12:15]
    v_mov_b32_dpp v16, v8 quad_perm:[0,0,0,0] row_mask:0xf bank_mask:0xf
    s_cmp_gt_i32 s69, 18
    s_cbranch_scc1 L_h_242
    s_waitcnt vmcnt(4)
L_h_242:
    s_waitcnt vmcnt(5)
    buffer_load_dwordx4 v[72:75], v3, s[36:39], s48 offen offset:0 nt
    v_mfma_f32_16x16x32_bf16 v[12:15], v[104:107], v[40:43], v[12:15]
    v_mov_b32_dpp v17, v9 quad_perm:[1,1,1,1] row_mask:0xf bank_mask:0xf
    s_cmp_gt_i32 s69, 19
    s_cbranch_scc1 L_h_244
    s_waitcnt vmcnt(4)
L_h_244:
    s_waitcnt vmcnt(5)
    buffer_load_dwordx4 v[76:79], v3, s[36:39], s48 offen offset:256 nt
    s_xor_b32 s48, s48, s13
    v_mov_b32 v4, s68
    s_mov_b64 exec, 1
    buffer_store_dword v4, off, s[64:67], s63 sc1
    s_mov_b64 exec, -1
    v_mfma_f32_16x16x32_bf16 v[12:15], v[108:111], v[44:47], v[12:15]
    v_add_f32_dpp v16, v10, v16 quad_perm:[2,2,2,2] row_mask:0xf bank_mask:0xf
    s_cmp_gt_i32 s69, 20
    s_cbranch_scc1 L_h_246
    s_waitcnt vmcnt(5)
L_h_246:
    s_waitcnt vmcnt(6)
    buffer_load_dwordx4 v[80:83], v3, s[36:39], s48 offen offset:0 nt
    s_mov_b64 exec, 0x7f
    buffer_load_dword v2, v1, s[64:67], 0 offen sc1
    s_mov_b64 exec, -1
    v_mfma_f32_16x16x32_bf16 v[12:15], v[112:115], v[48:51], v[12:15]
    v_add_f32_dpp v17, v11, v17 quad_perm:[3,3,3,3] row_mask:0xf bank_mask:0xf
    s_cmp_gt_i32 s69, 21
    s_cbranch_scc1 L_h_248
    s_waitcnt vmcnt(6)
L_h_248:
    s_waitcnt vmcnt(7)
    buffer_load_dwordx4 v[84:87], v3, s[36:39], s48 offen offset:256 nt
    s_xor_b32 s48, s48, s12
    v_mfma_f32_16x16x32_bf16 v[12:15], v[116:119], v[52:55], v[12:15]
    v_add_f32 v16, v16, v17
    s_cmp_gt_i32 s69, 22
    s_cbranch_scc1 L_h_250
    s_waitcnt vmcnt(6)
L_h_250:
    s_waitcnt vmcnt(7)
    buffer_load_dwordx4 v[88:91], v3, s[36:39], s48 offen offset:0 nt
    v_mfma_f32_16x16x32_bf16 v[12:15], v[120:123], v[56:59], v[12:15]
    ds_write_b32 v5, v16 offset:768
    s_cmp_gt_i32 s69, 23
    s_cbranch_scc1 L_h_252
    s_waitcnt vmcnt(6)
L_h_252:
    s_waitcnt vmcnt(7)
    buffer_load_dwordx4 v[92:95], v3, s[36:39], s48 offen offset:256 nt
    s_xor_b32 s48, s48, s14
    v_mfma_f32_16x16x32_bf16 v[12:15], v[124:127], v[60:63], v[12:15]
    s_cmp_gt_i32 s69, 24
    s_cbranch_scc1 L_h_254
    s_waitcnt vmcnt(6)
L_h_254:
    s_waitcnt vmcnt(7)
    buffer_load_dwordx4 v[96:99], v3, s[36:39], s48 offen offset:0 nt
    v_mfma_f32_16x16x32_bf16 v[8:11], v[64:67], v[32:35], 0
    s_cmp_gt_i32 s69, 25
    s_cbranch_scc1 L_h_256
    s_waitcnt vmcnt(5)
L_h_256:
    s_waitcnt vmcnt(7)
    buffer_load_dwordx4 v[100:103], v3, s[36:39], s48 offen offset:256 nt
    s_xor_b32 s48, s48, s12
    v_mfma_f32_16x16x32_bf16 v[8:11], v[68:71], v[36:39], v[8:11]
    v_mov_b32_dpp v16, v12 quad_perm:[0,0,0,0] row_mask:0xf bank_mask:0xf
    s_cmp_gt_i32 s69, 26
    s_cbranch_scc1 L_h_258
    s_waitcnt vmcnt(4)
L_h_258:
    s_waitcnt vmcnt(6)
    buffer_load_dwordx4 v[104:107], v3, s[36:39], s48 offen offset:0 nt
    v_mfma_f32_16x16x32_bf16 v[8:11], v[72:75], v[40:43], v[8:11]
    v_mov_b32_dpp v17, v13 quad_perm:[1,1,1,1] row_mask:0xf bank_mask:0xf
    s_cmp_gt_i32 s69, 27
    s_cbranch_scc1 L_h_260
    s_waitcnt vmcnt(4)
L_h_260:
    s_waitcnt vmcnt(5)
    buffer_load_dwordx4 v[108:111], v3, s[36:39], s48 offen offset:256 nt
    s_xor_b32 s48, s48, s13
    v_mfma_f32_16x16x32_bf16 v[8:11], v[76:79], v[44:47], v[8:11]
    v_add_f32_dpp v16, v14, v16 quad_perm:[2,2,2,2] row_mask:0xf bank_mask:0xf
    s_cmp_gt_i32 s69, 28
    s_cbranch_scc1 L_h_262
    s_waitcnt vmcnt(4)
L_h_262:
    s_waitcnt vmcnt(5)
    buffer_load_dwordx4 v[112:115], v3, s[36:39], s48 offen offset:0 nt
    s_cmp_eq_u32 s66, 0
    s_cbranch_scc1 L_nofb_264
    v_lshl_add_u32 v1, v0, 13, v1
    v_and_b32 v1, 0xffff, v1
    v_subrev_u32 v2, s68, v2
    v_cmp_gt_u32 s[22:23], 64, v2
    s_and_b32 s20, s22, 0x7f
    s_bcnt1_i32_b32 s20, s20
    s_cmp_lt_u32 s72, 2
    s_cselect_b64 s[26:27], s[6:7], s[4:5]
    s_lshl_b32 s20, s20, 3
    s_lshr_b64 s[26:27], s[26:27], s20
    s_sext_i32_i8 s26, s26
    v_mov_b32 v2, 16896
    v_mov_b32 v4, s26
    ds_write_b32 v2, v4 offset:16
L_nofb_264:
    s_add_u32 s68, s68, 1
    s_lshr_b32 s72, s72, 1
    s_bitcmp1_b32 s72, 0
    s_cselect_b32 s66, s71, 0
    v_mfma_f32_16x16x32_bf16 v[8:11], v[80:83], v[48:51], v[8:11]
    v_add_f32_dpp v17, v15, v17 quad_perm:[3,3,3,3] row_mask:0xf bank_mask:0xf
    s_cmp_gt_i32 s69, 29
    s_cbranch_scc1 L_h_265
    s_waitcnt vmcnt(4)
L_h_265:
    s_waitcnt vmcnt(5)
    buffer_load_dwordx4 v[116:119], v3, s[36:39], s48 offen offset:256 nt
    s_xor_b32 s48, s48, s12
    v_mfma_f32_16x16x32_bf16 v[8:11], v[84:87], v[52:55], v[8:11]
    v_add_f32 v16, v16, v17
    s_cmp_gt_i32 s69, 30
    s_cbranch_scc1 L_h_267
    s_waitcnt vmcnt(4)
L_h_267:
    s_waitcnt vmcnt(5)
    buffer_load_dwordx4 v[120:123], v3, s[36:39], s48 offen offset:0 nt
    v_mov_b32 v4, 16896
    v_mov_b32 v2, 1
    s_mov_b64 exec, 1
    ds_add_rtn_u32 v2, v4, v2 offset:20
    s_mov_b64 exec, -1
    ds_read_b32 v4, v4 offset:16
    v_mfma_f32_16x16x32_bf16 v[8:11], v[88:91], v[56:59], v[8:11]
    ds_write_b32 v5, v16 offset:784
    s_cmp_gt_i32 s69, 31
    s_cbranch_scc1 L_h_269
    s_waitcnt vmcnt(4)
L_h_269:
    s_waitcnt vmcnt(5)
    buffer_load_dwordx4 v[124:127], v3, s[36:39], s48 offen offset:256 nt
    s_waitcnt lgkmcnt(0)
    v_readfirstlane_b32 s69, v4
    v_readfirstlane_b32 s20, v2
    s_lshl_b32 s20, s20, 3
    s_lshr_b32 s20, s73, s20
    s_sext_i32_i8 s20, s20
    s_add_i32 s69, s69, s20
    s_sub_i32 s70, 0, s69
    v_mfma_f32_16x16x32_bf16 v[8:11], v[92:95], v[60:63], v[8:11]
    s_mov_b32 s48, s61
    v_and_b32 v18, 15, v0
    v_lshlrev_b32 v3, 4, v18
    v_lshrrev_b32 v18, 4, v0
    v_and_b32 v19, 1, v18
    v_lshl_add_u32 v3, v19, 16, v3
    v_lshrrev_b32 v19, 1, v18
    v_lshl_add_u32 v3, v19, 21, v3
    s_cmp_gt_i32 s69, 0
    s_cbranch_scc1 L_h_271
    s_cmp_gt_i32 s70, 0
    s_cbranch_scc0 L_m_272
    s_waitcnt vmcnt(3)
L_m_272:
    s_waitcnt vmcnt(4)
L_h_271:
    s_waitcnt vmcnt(5)
    buffer_load_dwordx4 v[64:67], v3, s[40:43], s48 offen offset:0 nt
    v_mfma_f32_16x16x32_bf16 v[12:15], v[96:99], v[32:35], 0
    s_cmp_gt_i32 s69, 1
    s_cbranch_scc1 L_h_273
    s_cmp_gt_i32 s70, 1
    s_cbranch_scc0 L_m_274
    s_waitcnt vmcnt(3)
L_m_274:
    s_waitcnt vmcnt(4)
L_h_273:
    s_waitcnt vmcnt(5)
    buffer_load_dwordx4 v[68:71], v3, s[40:43], s48 offen offset:256 nt
    s_xor_b32 s48, s48, s12
    v_mfma_f32_16x16x32_bf16 v[12:15], v[100:103], v[36:39], v[12:15]
    v_mov_b32_dpp v16, v8 quad_perm:[0,0,0,0] row_mask:0xf bank_mask:0xf
    s_cmp_gt_i32 s69, 2
    s_cbranch_scc1 L_h_275
    s_cmp_gt_i32 s70, 2
    s_cbranch_scc0 L_m_276
    s_waitcnt vmcnt(3)
L_m_276:
    s_waitcnt vmcnt(4)
L_h_275:
    s_waitcnt vmcnt(5)
    buffer_load_dwordx4 v[72:75], v3, s[40:43], s48 offen offset:0 nt
    v_mfma_f32_16x16x32_bf16 v[12:15], v[104:107], v[40:43], v[12:15]
    v_mov_b32_dpp v17, v9 quad_perm:[1,1,1,1] row_mask:0xf bank_mask:0xf
    s_cmp_gt_i32 s69, 3
    s_cbranch_scc1 L_h_277
    s_cmp_gt_i32 s70, 3
    s_cbranch_scc0 L_m_278
    s_waitcnt vmcnt(3)
L_m_278:
    s_waitcnt vmcnt(4)
L_h_277:
    s_waitcnt vmcnt(5)
    buffer_load_dwordx4 v[76:79], v3, s[40:43], s48 offen offset:256 nt
    s_xor_b32 s48, s48, s13
    v_mfma_f32_16x16x32_bf16 v[12:15], v[108:111], v[44:47], v[12:15]
    v_add_f32_dpp v16, v10, v16 quad_perm:[2,2,2,2] row_mask:0xf bank_mask:0xf
    s_cmp_gt_i32 s69, 4
    s_cbranch_scc1 L_h_279
    s_cmp_gt_i32 s70, 4
    s_cbranch_scc0 L_m_280
    s_waitcnt vmcnt(3)
L_m_280:
    s_waitcnt vmcnt(4)
L_h_279:
    s_waitcnt vmcnt(5)
    buffer_load_dwordx4 v[80:83], v3, s[40:43], s48 offen offset:0 nt
    v_mfma_f32_16x16x32_bf16 v[12:15], v[112:115], v[48:51], v[12:15]
    v_add_f32_dpp v17, v11, v17 quad_perm:[3,3,3,3] row_mask:0xf bank_mask:0xf
    s_cmp_gt_i32 s69, 5
    s_cbranch_scc1 L_h_281
    s_cmp_gt_i32 s70, 5
    s_cbranch_scc0 L_m_282
    s_waitcnt vmcnt(3)
L_m_282:
    s_waitcnt vmcnt(4)
L_h_281:
    s_waitcnt vmcnt(5)
    buffer_load_dwordx4 v[84:87], v3, s[40:43], s48 offen offset:256 nt
    s_xor_b32 s48, s48, s12
    v_mfma_f32_16x16x32_bf16 v[12:15], v[116:119], v[52:55], v[12:15]
    v_add_f32 v16, v16, v17
    s_cmp_gt_i32 s69, 6
    s_cbranch_scc1 L_h_283
    s_cmp_gt_i32 s70, 6
    s_cbranch_scc0 L_m_284
    s_waitcnt vmcnt(3)
L_m_284:
    s_waitcnt vmcnt(4)
L_h_283:
    s_waitcnt vmcnt(5)
    buffer_load_dwordx4 v[88:91], v3, s[40:43], s48 offen offset:0 nt
    v_mfma_f32_16x16x32_bf16 v[12:15], v[120:123], v[56:59], v[12:15]
    ds_write_b32 v5, v16 offset:800
    s_cmp_gt_i32 s69, 7
    s_cbranch_scc1 L_h_285
    s_cmp_gt_i32 s70, 7
    s_cbranch_scc0 L_m_286
    s_waitcnt vmcnt(3)
L_m_286:
    s_waitcnt vmcnt(4)
L_h_285:
    s_waitcnt vmcnt(5)
    buffer_load_dwordx4 v[92:95], v3, s[40:43], s48 offen offset:256 nt
    s_xor_b32 s48, s48, s14
    v_mfma_f32_16x16x32_bf16 v[12:15], v[124:127], v[60:63], v[12:15]
    s_nop 7
    v_mov_b32_dpp v16, v12 quad_perm:[0,0,0,0] row_mask:0xf bank_mask:0xf
    v_mov_b32_dpp v17, v13 quad_perm:[1,1,1,1] row_mask:0xf bank_mask:0xf
    s_nop 0
    v_add_f32_dpp v16, v14, v16 quad_perm:[2,2,2,2] row_mask:0xf bank_mask:0xf
    v_add_f32_dpp v17, v15, v17 quad_perm:[3,3,3,3] row_mask:0xf bank_mask:0xf
    v_add_f32 v16, v16, v17
    ds_write_b32 v5, v16 offset:816
    s_waitcnt lgkmcnt(0)
    s_barrier
    s_branch L_brk2_287s
L_brk2_287:
    s_setpc_b64 s[4:5]
L_brk2_287s:
    s_branch L_brk2_288s
L_brk2_288:
    s_setpc_b64 s[4:5]
L_brk2_288s:
    s_cmp_gt_i32 s69, 8
    s_cbranch_scc1 L_h_289
    s_cmp_gt_i32 s70, 8
    s_cbranch_scc0 L_m_290
    s_waitcnt vmcnt(3)
L_m_290:
    s_waitcnt vmcnt(4)
L_h_289:
    s_waitcnt vmcnt(5)
    buffer_load_dwordx4 v[96:99], v3, s[40:43], s48 offen offset:0 nt
    s_cmp_gt_i32 s69, 9
    s_cbranch_scc1 L_h_291
    s_cmp_gt_i32 s70, 9
    s_cbranch_scc0 L_m_292
    s_waitcnt vmcnt(3)
L_m_292:
    s_waitcnt vmcnt(4)
L_h_291:
    s_waitcnt vmcnt(5)
    buffer_load_dwordx4 v[100:103], v3, s[40:43], s48 offen offset:256 nt
    s_xor_b32 s48, s48, s12
    s_cmp_gt_i32 s69, 10
    s_cbranch_scc1 L_h_293
    s_cmp_gt_i32 s70, 10
    s_cbranch_scc0 L_m_294
    s_waitcnt vmcnt(3)
L_m_294:
    s_waitcnt vmcnt(4)
L_h_293:
    s_waitcnt vmcnt(5)
    buffer_load_dwordx4 v[104:107], v3, s[40:43], s48 offen offset:0 nt
    s_cmp_gt_i32 s69, 11
    s_cbranch_scc1 L_h_295
    s_cmp_gt_i32 s70, 11
    s_cbranch_scc0 L_m_296
    s_waitcnt vmcnt(3)
L_m_296:
    s_waitcnt vmcnt(4)
L_h_295:
    s_waitcnt vmcnt(5)
    buffer_load_dwordx4 v[108:111], v3, s[40:43], s48 offen offset:256 nt
    s_xor_b32 s48, s48, s13
    s_cmp_gt_i32 s69, 12
    s_cbranch_scc1 L_h_297
    s_cmp_gt_i32 s70, 12
    s_cbranch_scc0 L_m_298
    s_waitcnt vmcnt(3)
L_m_298:
    s_waitcnt vmcnt(4)
L_h_297:
    s_waitcnt vmcnt(5)
    buffer_load_dwordx4 v[112:115], v3, s[40:43], s48 offen offset:0 nt
    s_cmp_gt_i32 s69, 13
    s_cbranch_scc1 L_h_299
    s_cmp_gt_i32 s70, 13
    s_cbranch_scc0 L_m_300
    s_waitcnt vmcnt(3)
L_m_300:
    s_waitcnt vmcnt(4)
L_h_299:
    s_waitcnt vmcnt(5)
    buffer_load_dwordx4 v[116:119], v3, s[40:43], s48 offen offset:256 nt
    s_xor_b32 s48, s48, s12
    s_cmp_gt_i32 s69, 14
    s_cbranch_scc1 L_h_301
    s_cmp_gt_i32 s70, 14
    s_cbranch_scc0 L_m_302
    s_waitcnt vmcnt(3)
L_m_302:
    s_waitcnt vmcnt(4)
L_h_301:
    s_waitcnt vmcnt(5)
    buffer_load_dwordx4 v[120:123], v3, s[40:43], s48 offen offset:0 nt
    s_cmp_gt_i32 s69, 15
    s_cbranch_scc1 L_h_303
    s_cmp_gt_i32 s70, 15
    s_cbranch_scc0 L_m_304
    s_waitcnt vmcnt(3)
L_m_304:
    s_waitcnt vmcnt(4)
L_h_303:
    s_waitcnt vmcnt(5)
    buffer_load_dwordx4 v[124:127], v3, s[40:43], s48 offen offset:256 nt
    s_xor_b32 s48, s48, s15
    s_cmp_gt_i32 s69, 16
    s_cbranch_scc1 L_h_305
    s_waitcnt vmcnt(4)
L_h_305:
    s_waitcnt vmcnt(5)
    buffer_load_dwordx4 v[128:131], v3, s[40:43], s48 offen offset:0 nt
    s_cmp_gt_i32 s69, 17
    s_cbranch_scc1 L_h_307
    s_waitcnt vmcnt(4)
L_h_307:
    s_waitcnt vmcnt(5)
    buffer_load_dwordx4 v[132:135], v3, s[40:43], s48 offen offset:256 nt
    s_xor_b32 s48, s48, s12
    s_cmp_gt_i32 s69, 18
    s_cbranch_scc1 L_h_309
    s_waitcnt vmcnt(4)
L_h_309:
    s_waitcnt vmcnt(5)
    buffer_load_dwordx4 v[136:139], v3, s[40:43], s48 offen offset:0 nt
    s_cmp_gt_i32 s69, 19
    s_cbranch_scc1 L_h_311
    s_waitcnt vmcnt(4)
L_h_311:
    s_waitcnt vmcnt(5)
    buffer_load_dwordx4 v[140:143], v3, s[40:43], s48 offen offset:256 nt
    s_xor_b32 s48, s48, s13
    v_mov_b32 v4, s68
    s_mov_b64 exec, 1
    buffer_store_dword v4, off, s[64:67], s63 sc1
    s_mov_b64 exec, -1
    s_cmp_gt_i32 s69, 20
    s_cbranch_scc1 L_h_313
    s_waitcnt vmcnt(5)
L_h_313:
    s_waitcnt vmcnt(6)
    buffer_load_dwordx4 v[144:147], v3, s[40:43], s48 offen offset:0 nt
    s_mov_b64 exec, 0x7f
    buffer_load_dword v2, v1, s[64:67], 0 offen sc1
    s_mov_b64 exec, -1
    s_cmp_gt_i32 s69, 21
    s_cbranch_scc1 L_h_315
    s_waitcnt vmcnt(6)
L_h_315:
    s_waitcnt vmcnt(7)
    buffer_load_dwordx4 v[148:151], v3, s[40:43], s48 offen offset:256 nt
    s_xor_b32 s48, s48, s12
    s_cmp_gt_i32 s69, 22
    s_cbranch_scc1 L_h_317
    s_waitcnt vmcnt(6)
L_h_317:
    s_waitcnt vmcnt(7)
    buffer_load_dwordx4 v[152:155], v3, s[40:43], s48 offen offset:0 nt
    s_cmp_gt_i32 s69, 23
    s_cbranch_scc1 L_h_319
    s_waitcnt vmcnt(6)
L_h_319:
    s_waitcnt vmcnt(7)
    buffer_load_dwordx4 v[156:159], v3, s[40:43], s48 offen offset:256 nt
    s_xor_b32 s48, s48, s14
    s_cmp_gt_i32 s69, 24
    s_cbranch_scc1 L_h_321
    s_waitcnt vmcnt(6)
L_h_321:
    s_waitcnt vmcnt(7)
    buffer_load_dwordx4 v[160:163], v3, s[40:43], s48 offen offset:0 nt
    s_cmp_gt_i32 s69, 25
    s_cbranch_scc1 L_h_323
    s_waitcnt vmcnt(5)
L_h_323:
    s_waitcnt vmcnt(7)
    buffer_load_dwordx4 v[164:167], v3, s[40:43], s48 offen offset:256 nt
    s_xor_b32 s48, s48, s12
    s_cmp_gt_i32 s69, 26
    s_cbranch_scc1 L_h_325
    s_waitcnt vmcnt(4)
L_h_325:
    s_waitcnt vmcnt(6)
    buffer_load_dwordx4 v[168:171], v3, s[40:43], s48 offen offset:0 nt
    s_cmp_gt_i32 s69, 27
    s_cbranch_scc1 L_h_327
    s_waitcnt vmcnt(4)
L_h_327:
    s_waitcnt vmcnt(5)
    buffer_load_dwordx4 v[172:175], v3, s[40:43], s48 offen offset:256 nt
    s_xor_b32 s48, s48, s13
    s_cmp_gt_i32 s69, 28
    s_cbranch_scc1 L_h_329
    s_waitcnt vmcnt(4)
L_h_329:
    s_waitcnt vmcnt(5)
    buffer_load_dwordx4 v[176:179], v3, s[40:43], s48 offen offset:0 nt
    s_cmp_eq_u32 s66, 0
    s_cbranch_scc1 L_nofb_331
    v_lshl_add_u32 v1, v0, 13, v1
    v_and_b32 v1, 0xffff, v1
    v_subrev_u32 v2, s68, v2
    v_cmp_gt_u32 s[22:23], 64, v2
    s_and_b32 s20, s22, 0x7f
    s_bcnt1_i32_b32 s20, s20
    s_cmp_lt_u32 s72, 2
    s_cselect_b64 s[26:27], s[6:7], s[4:5]
    s_lshl_b32 s20, s20, 3
    s_lshr_b64 s[26:27], s[26:27], s20
    s_sext_i32_i8 s26, s26
    v_mov_b32 v2, 16896
    v_mov_b32 v4, s26
    ds_write_b32 v2, v4 offset:16
L_nofb_331:
    s_add_u32 s68, s68, 1
    s_lshr_b32 s72, s72, 1
    s_bitcmp1_b32 s72, 0
    s_cselect_b32 s66, s71, 0
    s_cmp_gt_i32 s69, 29
    s_cbranch_scc1 L_h_332
    s_waitcnt vmcnt(4)
L_h_332:
    s_waitcnt vmcnt(5)
    buffer_load_dwordx4 v[180:183], v3, s[40:43], s48 offen offset:256 nt
    s_xor_b32 s48, s48, s12
    s_cmp_gt_i32 s69, 30
    s_cbranch_scc1 L_h_334
    s_waitcnt vmcnt(4)
L_h_334:
    s_waitcnt vmcnt(5)
    buffer_load_dwordx4 v[184:187], v3, s[40:43], s48 offen offset:0 nt
    v_mov_b32 v4, 16896
    v_mov_b32 v2, 1
    s_mov_b64 exec, 1
    ds_add_rtn_u32 v2, v4, v2 offset:20
    s_mov_b64 exec, -1
    ds_read_b32 v4, v4 offset:16
    s_cmp_gt_i32 s69, 31
    s_cbranch_scc1 L_h_336
    s_waitcnt vmcnt(4)
L_h_336:
    s_waitcnt vmcnt(5)
    buffer_load_dwordx4 v[188:191], v3, s[40:43], s48 offen offset:256 nt
    s_xor_b32 s48, s48, s16
    s_waitcnt lgkmcnt(0)
    v_readfirstlane_b32 s69, v4
    v_readfirstlane_b32 s20, v2
    s_lshl_b32 s20, s20, 3
    s_lshr_b32 s20, s73, s20
    s_sext_i32_i8 s20, s20
    s_add_i32 s69, s69, s20
    s_sub_i32 s70, 0, s69
    s_cmp_gt_i32 s69, 0
    s_cbranch_scc1 L_h_338
    s_cmp_gt_i32 s70, 0
    s_cbranch_scc0 L_m_339
    s_waitcnt vmcnt(3)
L_m_339:
    s_waitcnt vmcnt(4)
L_h_338:
    s_waitcnt vmcnt(5)
    buffer_load_dwordx4 v[192:195], v3, s[40:43], s48 offen offset:0 nt
    s_cmp_gt_i32 s69, 1
    s_cbranch_scc1 L_h_340
    s_cmp_gt_i32 s70, 1
    s_cbranch_scc0 L_m_341
    s_waitcnt vmcnt(3)
L_m_341:
    s_waitcnt vmcnt(4)
L_h_340:
    s_waitcnt vmcnt(5)
    buffer_load_dwordx4 v[196:199], v3, s[40:43], s48 offen offset:256 nt
    s_xor_b32 s48, s48, s12
    s_cmp_gt_i32 s69, 2
    s_cbranch_scc1 L_h_342
    s_cmp_gt_i32 s70, 2
    s_cbranch_scc0 L_m_343
    s_waitcnt vmcnt(3)
L_m_343:
    s_waitcnt vmcnt(4)
L_h_342:
    s_waitcnt vmcnt(5)
    buffer_load_dwordx4 v[200:203], v3, s[40:43], s48 offen offset:0 nt
    s_cmp_gt_i32 s69, 3
    s_cbranch_scc1 L_h_344
    s_cmp_gt_i32 s70, 3
    s_cbranch_scc0 L_m_345
    s_waitcnt vmcnt(3)
L_m_345:
    s_waitcnt vmcnt(4)
L_h_344:
    s_waitcnt vmcnt(5)
    buffer_load_dwordx4 v[204:207], v3, s[40:43], s48 offen offset:256 nt
    s_xor_b32 s48, s48, s13
    s_cmp_gt_i32 s69, 4
    s_cbranch_scc1 L_h_346
    s_cmp_gt_i32 s70, 4
    s_cbranch_scc0 L_m_347
    s_waitcnt vmcnt(3)
L_m_347:
    s_waitcnt vmcnt(4)
L_h_346:
    s_waitcnt vmcnt(5)
    buffer_load_dwordx4 v[208:211], v3, s[40:43], s48 offen offset:0 nt
    s_cmp_gt_i32 s69, 5
    s_cbranch_scc1 L_h_348
    s_cmp_gt_i32 s70, 5
    s_cbranch_scc0 L_m_349
    s_waitcnt vmcnt(3)
L_m_349:
    s_waitcnt vmcnt(4)
L_h_348:
    s_waitcnt vmcnt(5)
    buffer_load_dwordx4 v[212:215], v3, s[40:43], s48 offen offset:256 nt
    s_xor_b32 s48, s48, s12
    s_cmp_gt_i32 s69, 6
    s_cbranch_scc1 L_h_350
    s_cmp_gt_i32 s70, 6
    s_cbranch_scc0 L_m_351
    s_waitcnt vmcnt(3)
L_m_351:
    s_waitcnt vmcnt(4)
L_h_350:
    s_waitcnt vmcnt(5)
    buffer_load_dwordx4 v[216:219], v3, s[40:43], s48 offen offset:0 nt
    s_cmp_gt_i32 s69, 7
    s_cbranch_scc1 L_h_352
    s_cmp_gt_i32 s70, 7
    s_cbranch_scc0 L_m_353
    s_waitcnt vmcnt(3)
L_m_353:
    s_waitcnt vmcnt(4)
L_h_352:
    s_waitcnt vmcnt(5)
    buffer_load_dwordx4 v[220:223], v3, s[40:43], s48 offen offset:256 nt
    s_xor_b32 s48, s48, s14
    s_branch L_brk2_354s
L_brk2_354:
    s_setpc_b64 s[4:5]
L_brk2_354s:
    s_cmp_gt_i32 s69, 8
    s_cbranch_scc1 L_h_355
    s_cmp_gt_i32 s70, 8
    s_cbranch_scc0 L_m_356
    s_waitcnt vmcnt(3)
L_m_356:
    s_waitcnt vmcnt(4)
L_h_355:
    s_waitcnt vmcnt(5)
    buffer_load_dwordx4 v[224:227], v3, s[40:43], s48 offen offset:0 nt
    s_cmp_gt_i32 s69, 9
    s_cbranch_scc1 L_h_357
    s_cmp_gt_i32 s70, 9
    s_cbranch_scc0 L_m_358
    s_waitcnt vmcnt(3)
L_m_358:
    s_waitcnt vmcnt(4)
L_h_357:
    s_waitcnt vmcnt(5)
    buffer_load_dwordx4 v[228:231], v3, s[40:43], s48 offen offset:256 nt
    s_xor_b32 s48, s48, s12
    s_cmp_gt_i32 s69, 10
    s_cbranch_scc1 L_h_359
    s_cmp_gt_i32 s70, 10
    s_cbranch_scc0 L_m_360
    s_waitcnt vmcnt(3)
L_m_360:
    s_waitcnt vmcnt(4)
L_h_359:
    s_waitcnt vmcnt(5)
    buffer_load_dwordx4 v[232:235], v3, s[40:43], s48 offen offset:0 nt
    s_cmp_gt_i32 s69, 11
    s_cbranch_scc1 L_h_361
    s_cmp_gt_i32 s70, 11
    s_cbranch_scc0 L_m_362
    s_waitcnt vmcnt(3)
L_m_362:
    s_waitcnt vmcnt(4)
L_h_361:
    s_waitcnt vmcnt(5)
    buffer_load_dwordx4 v[236:239], v3, s[40:43], s48 offen offset:256 nt
    s_xor_b32 s48, s48, s13
    s_branch L_brk2_363s
.p2align 12
L_brk2_363:
    s_setpc_b64 s[4:5]
L_brk2_363s:
    s_barrier
    ds_read_b32 v18, v6 offset:0
    ds_read_b32 v19, v6 offset:256
    s_cmp_gt_i32 s69, 12
    s_cbranch_scc1 L_h_364
    s_cmp_gt_i32 s70, 12
    s_cbranch_scc0 L_m_365
    s_waitcnt vmcnt(3)
L_m_365:
    s_waitcnt vmcnt(4)
L_h_364:
    s_waitcnt vmcnt(5)
    buffer_load_dwordx4 v[240:243], v3, s[40:43], s48 offen offset:0 nt
    s_cmp_gt_i32 s69, 13
    s_cbranch_scc1 L_h_366
    s_cmp_gt_i32 s70, 13
    s_cbranch_scc0 L_m_367
    s_waitcnt vmcnt(3)
L_m_367:
    s_waitcnt vmcnt(4)
L_h_366:
    s_waitcnt vmcnt(5)
    buffer_load_dwordx4 v[244:247], v3, s[40:43], s48 offen offset:256 nt
    s_xor_b32 s48, s48, s12
    s_cmp_gt_i32 s69, 14
    s_cbranch_scc1 L_h_368
    s_cmp_gt_i32 s70, 14
    s_cbranch_scc0 L_m_369
    s_waitcnt vmcnt(3)
L_m_369:
    s_waitcnt vmcnt(4)
L_h_368:
    s_waitcnt vmcnt(5)
    buffer_load_dwordx4 v[248:251], v3, s[40:43], s48 offen offset:0 nt
    s_cmp_gt_i32 s69, 15
    s_cbranch_scc1 L_h_370
    s_cmp_gt_i32 s70, 15
    s_cbranch_scc0 L_m_371
    s_waitcnt vmcnt(3)
L_m_371:
    s_waitcnt vmcnt(4)
L_h_370:
    s_waitcnt vmcnt(5)
    buffer_load_dwordx4 v[252:255], v3, s[40:43], s48 offen offset:256 nt
    s_xor_b32 s48, s48, s15
    s_waitcnt lgkmcnt(0)
    v_and_b32_dpp v24, v18, v20 row_newbcast:0 row_mask:0xf bank_mask:0xf
    v_and_b32_dpp v25, v18, v21 row_newbcast:0 row_mask:0xf bank_mask:0xf
    v_and_b32_dpp v26, v18, v22 row_newbcast:0 row_mask:0xf bank_mask:0xf
    v_and_b32_dpp v27, v18, v23 row_newbcast:0 row_mask:0xf bank_mask:0xf
    s_nop 1
    v_mfma_f32_16x16x32_bf16 v[8:11], v[24:27], v[64:67], 0
    v_and_b32_dpp v28, v18, v20 row_newbcast:1 row_mask:0xf bank_mask:0xf
    v_and_b32_dpp v29, v18, v21 row_newbcast:1 row_mask:0xf bank_mask:0xf
    v_and_b32_dpp v30, v18, v22 row_newbcast:1 row_mask:0xf bank_mask:0xf
    v_and_b32_dpp v31, v18, v23 row_newbcast:1 row_mask:0xf bank_mask:0xf
    s_cmp_gt_i32 s69, 16
    s_cbranch_scc1 L_h_372
    s_waitcnt vmcnt(4)
L_h_372:
    s_waitcnt vmcnt(5)
    buffer_load_dwordx4 v[64:67], v3, s[40:43], s48 offen offset:0 nt
    v_mfma_f32_16x16x32_bf16 v[12:15], v[24:27], v[68:71], 0
    s_cmp_gt_i32 s69, 17
    s_cbranch_scc1 L_h_374
    s_waitcnt vmcnt(4)
L_h_374:
    s_waitcnt vmcnt(5)
    buffer_load_dwordx4 v[68:71], v3, s[40:43], s48 offen offset:256 nt
    s_xor_b32 s48, s48, s12
    v_mfma_f32_16x16x32_bf16 v[8:11], v[28:31], v[72:75], v[8:11]
    v_and_b32_dpp v24, v18, v20 row_newbcast:2 row_mask:0xf bank_mask:0xf
    v_and_b32_dpp v25, v18, v21 row_newbcast:2 row_mask:0xf bank_mask:0xf
    v_and_b32_dpp v26, v18, v22 row_newbcast:2 row_mask:0xf bank_mask:0xf
    v_and_b32_dpp v27, v18, v23 row_newbcast:2 row_mask:0xf bank_mask:0xf
    s_cmp_gt_i32 s69, 18
    s_cbranch_scc1 L_h_376
    s_waitcnt vmcnt(4)
L_h_376:
    s_waitcnt vmcnt(5)
    buffer_load_dwordx4 v[72:75], v3, s[40:43], s48 offen offset:0 nt
    v_mfma_f32_16x16x32_bf16 v[12:15], v[28:31], v[76:79], v[12:15]
    s_cmp_gt_i32 s69, 19
    s_cbranch_scc1 L_h_378
    s_waitcnt vmcnt(4)
L_h_378:
    s_waitcnt vmcnt(5)
    buffer_load_dwordx4 v[76:79], v3, s[40:43], s48 offen offset:256 nt
    s_xor_b32 s48, s48, s13
    v_mov_b32 v4, s68
    s_mov_b64 exec, 1
    buffer_store_dword v4, off, s[64:67], s63 sc1
    s_mov_b64 exec, -1
    v_mfma_f32_16x16x32_bf16 v[8:11], v[24:27], v[80:83], v[8:11]
    v_and_b32_dpp v28, v18, v20 row_newbcast:3 row_mask:0xf bank_mask:0xf
    v_and_b32_dpp v29, v18, v21 row_newbcast:3 row_mask:0xf bank_mask:0xf
    v_and_b32_dpp v30, v18, v22 row_newbcast:3 row_mask:0xf bank_mask:0xf
    v_and_b32_dpp v31, v18, v23 row_newbcast:3 row_mask:0xf bank_mask:0xf
    s_cmp_gt_i32 s69, 20
    s_cbranch_scc1 L_h_380
    s_waitcnt vmcnt(5)
L_h_380:
    s_waitcnt vmcnt(6)
    buffer_load_dwordx4 v[80:83], v3, s[40:43], s48 offen offset:0 nt
    s_mov_b64 exec, 0x7f
    buffer_load_dword v2, v1, s[64:67], 0 offen sc1
    s_mov_b64 exec, -1
    v_mfma_f32_16x16x32_bf16 v[12:15], v[24:27], v[84:87], v[12:15]
    v_mfma_f32_16x16x32_bf16 v[8:11], v[28:31], v[88:91], v[8:11]
    v_and_b32_dpp v24, v18, v20 row_newbcast:4 row_mask:0xf bank_mask:0xf
    v_and_b32_dpp v25, v18, v21 row_newbcast:4 row_mask:0xf bank_mask:0xf
    v_and_b32_dpp v26, v18, v22 row_newbcast:4 row_mask:0xf bank_mask:0xf
    v_and_b32_dpp v27, v18, v23 row_newbcast:4 row_mask:0xf bank_mask:0xf
    v_mfma_f32_16x16x32_bf16 v[12:15], v[28:31], v[92:95], v[12:15]
    s_nop 0
    v_mfma_f32_16x16x32_bf16 v[8:11], v[24:27], v[96:99], v[8:11]
    v_and_b32_dpp v28, v18, v20 row_newbcast:5 row_mask:0xf bank_mask:0xf
    v_and_b32_dpp v29, v18, v21 row_newbcast:5 row_mask:0xf bank_mask:0xf
    v_and_b32_dpp v30, v18, v22 row_newbcast:5 row_mask:0xf bank_mask:0xf
    v_and_b32_dpp v31, v18, v23 row_newbcast:5 row_mask:0xf bank_mask:0xf
    v_mfma_f32_16x16x32_bf16 v[12:15], v[24:27], v[100:103], v[12:15]
    s_nop 0
    v_mfma_f32_16x16x32_bf16 v[8:11], v[28:31], v[104:107], v[8:11]
    v_and_b32_dpp v24, v18, v20 row_newbcast:6 row_mask:0xf bank_mask:0xf
    v_and_b32_dpp v25, v18, v21 row_newbcast:6 row_mask:0xf bank_mask:0xf
    v_and_b32_dpp v26, v18, v22 row_newbcast:6 row_mask:0xf bank_mask:0xf
    v_and_b32_dpp v27, v18, v23 row_newbcast:6 row_mask:0xf bank_mask:0xf
    v_mfma_f32_16x16x32_bf16 v[12:15], v[28:31], v[108:111], v[12:15]
    s_nop 0
    v_mfma_f32_16x16x32_bf16 v[8:11], v[24:27], v[112:115], v[8:11]
    v_and_b32_dpp v28, v18, v20 row_newbcast:7 row_mask:0xf bank_mask:0xf
    v_and_b32_dpp v29, v18, v21 row_newbcast:7 row_mask:0xf bank_mask:0xf
    v_and_b32_dpp v30, v18, v22 row_newbcast:7 row_mask:0xf bank_mask:0xf
    v_and_b32_dpp v31, v18, v23 row_newbcast:7 row_mask:0xf bank_mask:0xf
    s_cmp_gt_i32 s69, 21
    s_cbranch_scc1 L_h_382
    s_waitcnt vmcnt(6)
L_h_382:
    s_waitcnt vmcnt(7)
    buffer_load_dwordx4 v[84:87], v3, s[40:43], s48 offen offset:256 nt
    s_xor_b32 s48, s48, s12
    v_mfma_f32_16x16x32_bf16 v[12:15], v[24:27], v[116:119], v[12:15]
    v_mfma_f32_16x16x32_bf16 v[8:11], v[28:31], v[120:123], v[8:11]
    v_and_b32_dpp v24, v18, v20 row_newbcast:8 row_mask:0xf bank_mask:0xf
    v_and_b32_dpp v25, v18, v21 row_newbcast:8 row_mask:0xf bank_mask:0xf
    v_and_b32_dpp v26, v18, v22 row_newbcast:8 row_mask:0xf bank_mask:0xf
    v_and_b32_dpp v27, v18, v23 row_newbcast:8 row_mask:0xf bank_mask:0xf
    v_mfma_f32_16x16x32_bf16 v[12:15], v[28:31], v[124:127], v[12:15]
    s_nop 0
    v_mfma_f32_16x16x32_bf16 v[8:11], v[24:27], v[128:131], v[8:11]
    v_and_b32_dpp v28, v18, v20 row_newbcast:9 row_mask:0xf bank_mask:0xf
    v_and_b32_dpp v29, v18, v21 row_newbcast:9 row_mask:0xf bank_mask:0xf
    v_and_b32_dpp v30, v18, v22 row_newbcast:9 row_mask:0xf bank_mask:0xf
    v_and_b32_dpp v31, v18, v23 row_newbcast:9 row_mask:0xf bank_mask:0xf
    v_mfma_f32_16x16x32_bf16 v[12:15], v[24:27], v[132:135], v[12:15]
    s_nop 0
    v_mfma_f32_16x16x32_bf16 v[8:11], v[28:31], v[136:139], v[8:11]
    v_and_b32_dpp v24, v18, v20 row_newbcast:10 row_mask:0xf bank_mask:0xf
    v_and_b32_dpp v25, v18, v21 row_newbcast:10 row_mask:0xf bank_mask:0xf
    v_and_b32_dpp v26, v18, v22 row_newbcast:10 row_mask:0xf bank_mask:0xf
    v_and_b32_dpp v27, v18, v23 row_newbcast:10 row_mask:0xf bank_mask:0xf
    v_mfma_f32_16x16x32_bf16 v[12:15], v[28:31], v[140:143], v[12:15]
    s_nop 0
    v_mfma_f32_16x16x32_bf16 v[8:11], v[24:27], v[144:147], v[8:11]
    v_and_b32_dpp v28, v18, v20 row_newbcast:11 row_mask:0xf bank_mask:0xf
    v_and_b32_dpp v29, v18, v21 row_newbcast:11 row_mask:0xf bank_mask:0xf
    v_and_b32_dpp v30, v18, v22 row_newbcast:11 row_mask:0xf bank_mask:0xf
    v_and_b32_dpp v31, v18, v23 row_newbcast:11 row_mask:0xf bank_mask:0xf
    s_cmp_gt_i32 s69, 22
    s_cbranch_scc1 L_h_384
    s_waitcnt vmcnt(6)
L_h_384:
    s_waitcnt vmcnt(7)
    buffer_load_dwordx4 v[88:91], v3, s[40:43], s48 offen offset:0 nt
    v_mfma_f32_16x16x32_bf16 v[12:15], v[24:27], v[148:151], v[12:15]
    v_mfma_f32_16x16x32_bf16 v[8:11], v[28:31], v[152:155], v[8:11]
    v_and_b32_dpp v24, v18, v20 row_newbcast:12 row_mask:0xf bank_mask:0xf
    v_and_b32_dpp v25, v18, v21 row_newbcast:12 row_mask:0xf bank_mask:0xf
    v_and_b32_dpp v26, v18, v22 row_newbcast:12 row_mask:0xf bank_mask:0xf
    v_and_b32_dpp v27, v18, v23 row_newbcast:12 row_mask:0xf bank_mask:0xf
    v_mfma_f32_16x16x32_bf16 v[12:15], v[28:31], v[156:159], v[12:15]
    s_nop 0
    v_mfma_f32_16x16x32_bf16 v[8:11], v[24:27], v[160:163], v[8:11]
    v_and_b32_dpp v28, v18, v20 row_newbcast:13 row_mask:0xf bank_mask:0xf
    v_and_b32_dpp v29, v18, v21 row_newbcast:13 row_mask:0xf bank_mask:0xf
    v_and_b32_dpp v30, v18, v22 row_newbcast:13 row_mask:0xf bank_mask:0xf
    v_and_b32_dpp v31, v18, v23 row_newbcast:13 row_mask:0xf bank_mask:0xf
    v_mfma_f32_16x16x32_bf16 v[12:15], v[24:27], v[164:167], v[12:15]
    s_nop 0
    v_mfma_f32_16x16x32_bf16 v[8:11], v[28:31], v[168:171], v[8:11]
    v_and_b32_dpp v24, v18, v20 row_newbcast:14 row_mask:0xf bank_mask:0xf
    v_and_b32_dpp v25, v18, v21 row_newbcast:14 row_mask:0xf bank_mask:0xf
    v_and_b32_dpp v26, v18, v22 row_newbcast:14 row_mask:0xf bank_mask:0xf
    v_and_b32_dpp v27, v18, v23 row_newbcast:14 row_mask:0xf bank_mask:0xf
    v_mfma_f32_16x16x32_bf16 v[12:15], v[28:31], v[172:175], v[12:15]
    s_nop 0
    v_mfma_f32_16x16x32_bf16 v[8:11], v[24:27], v[176:179], v[8:11]
    v_and_b32_dpp v28, v18, v20 row_newbcast:15 row_mask:0xf bank_mask:0xf
    v_and_b32_dpp v29, v18, v21 row_newbcast:15 row_mask:0xf bank_mask:0xf
    v_and_b32_dpp v30, v18, v22 row_newbcast:15 row_mask:0xf bank_mask:0xf
    v_and_b32_dpp v31, v18, v23 row_newbcast:15 row_mask:0xf bank_mask:0xf
    s_cmp_gt_i32 s69, 23
    s_cbranch_scc1 L_h_386
    s_waitcnt vmcnt(6)
L_h_386:
    s_waitcnt vmcnt(7)
    buffer_load_dwordx4 v[92:95], v3, s[40:43], s48 offen offset:256 nt
    s_xor_b32 s48, s48, s14
    v_mfma_f32_16x16x32_bf16 v[12:15], v[24:27], v[180:183], v[12:15]
    v_mfma_f32_16x16x32_bf16 v[8:11], v[28:31], v[184:187], v[8:11]
    s_waitcnt lgkmcnt(0)
    v_mov_b32 v18, v19
    ds_read_b32 v19, v6 offset:512
    s_nop 0
    v_and_b32_dpp v24, v18, v20 row_newbcast:0 row_mask:0xf bank_mask:0xf
    v_and_b32_dpp v25, v18, v21 row_newbcast:0 row_mask:0xf bank_mask:0xf
    v_and_b32_dpp v26, v18, v22 row_newbcast:0 row_mask:0xf bank_mask:0xf
    v_and_b32_dpp v27, v18, v23 row_newbcast:0 row_mask:0xf bank_mask:0xf
    v_mfma_f32_16x16x32_bf16 v[12:15], v[28:31], v[188:191], v[12:15]
    s_nop 0
    v_mfma_f32_16x16x32_bf16 v[8:11], v[24:27], v[192:195], v[8:11]
    v_and_b32_dpp v28, v18, v20 row_newbcast:1 row_mask:0xf bank_mask:0xf
    v_and_b32_dpp v29, v18, v21 row_newbcast:1 row_mask:0xf bank_mask:0xf
    v_and_b32_dpp v30, v18, v22 row_newbcast:1 row_mask:0xf bank_mask:0xf
    v_and_b32_dpp v31, v18, v23 row_newbcast:1 row_mask:0xf bank_mask:0xf
    v_mfma_f32_16x16x32_bf16 v[12:15], v[24:27], v[196:199], v[12:15]
    s_nop 0
    v_mfma_f32_16x16x32_bf16 v[8:11], v[28:31], v[200:203], v[8:11]
    v_and_b32_dpp v24, v18, v20 row_newbcast:2 row_mask:0xf bank_mask:0xf
    v_and_b32_dpp v25, v18, v21 row_newbcast:2 row_mask:0xf bank_mask:0xf
    v_and_b32_dpp v26, v18, v22 row_newbcast:2 row_mask:0xf bank_mask:0xf
    v_and_b32_dpp v27, v18, v23 row_newbcast:2 row_mask:0xf bank_mask:0xf
    v_mfma_f32_16x16x32_bf16 v[12:15], v[28:31], v[204:207], v[12:15]
    s_nop 0
    v_mfma_f32_16x16x32_bf16 v[8:11], v[24:27], v[208:211], v[8:11]
    v_and_b32_dpp v28, v18, v20 row_newbcast:3 row_mask:0xf bank_mask:0xf
    v_and_b32_dpp v29, v18, v21 row_newbcast:3 row_mask:0xf bank_mask:0xf
    v_and_b32_dpp v30, v18, v22 row_newbcast:3 row_mask:0xf bank_mask:0xf
    v_and_b32_dpp v31, v18, v23 row_newbcast:3 row_mask:0xf bank_mask:0xf
    s_cmp_gt_i32 s69, 24
    s_cbranch_scc1 L_h_388
    s_waitcnt vmcnt(6)
L_h_388:
    s_waitcnt vmcnt(7)
    buffer_load_dwordx4 v[96:99], v3, s[40:43], s48 offen offset:0 nt
    s_branch L_brk2_390s
L_brk2_390:
    s_setpc_b64 s[4:5]
L_brk2_390s:
    v_mfma_f32_16x16x32_bf16 v[12:15], v[24:27], v[212:215], v[12:15]
    v_mfma_f32_16x16x32_bf16 v[8:11], v[28:31], v[216:219], v[8:11]
    v_and_b32_dpp v24, v18, v20 row_newbcast:4 row_mask:0xf bank_mask:0xf
    v_and_b32_dpp v25, v18, v21 row_newbcast:4 row_mask:0xf bank_mask:0xf
    v_and_b32_dpp v26, v18, v22 row_newbcast:4 row_mask:0xf bank_mask:0xf
    v_and_b32_dpp v27, v18, v23 row_newbcast:4 row_mask:0xf bank_mask:0xf
    v_mfma_f32_16x16x32_bf16 v[12:15], v[28:31], v[220:223], v[12:15]
    s_nop 0
    v_mfma_f32_16x16x32_bf16 v[8:11], v[24:27], v[224:227], v[8:11]
    v_and_b32_dpp v28, v18, v20 row_newbcast:5 row_mask:0xf bank_mask:0xf
    v_and_b32_dpp v29, v18, v21 row_newbcast:5 row_mask:0xf bank_mask:0xf
    v_and_b32_dpp v30, v18, v22 row_newbcast:5 row_mask:0xf bank_mask:0xf
    v_and_b32_dpp v31, v18, v23 row_newbcast:5 row_mask:0xf bank_mask:0xf
    v_mfma_f32_16x16x32_bf16 v[12:15], v[24:27], v[228:231], v[12:15]
    s_nop 0
    v_mfma_f32_16x16x32_bf16 v[8:11], v[28:31], v[232:235], v[8:11]
    v_and_b32_dpp v24, v18, v20 row_newbcast:6 row_mask:0xf bank_mask:0xf
    v_and_b32_dpp v25, v18, v21 row_newbcast:6 row_mask:0xf bank_mask:0xf
    v_and_b32_dpp v26, v18, v22 row_newbcast:6 row_mask:0xf bank_mask:0xf
    v_and_b32_dpp v27, v18, v23 row_newbcast:6 row_mask:0xf bank_mask:0xf
    v_mfma_f32_16x16x32_bf16 v[12:15], v[28:31], v[236:239], v[12:15]
    s_nop 0
    v_mfma_f32_16x16x32_bf16 v[8:11], v[24:27], v[240:243], v[8:11]
    v_and_b32_dpp v28, v18, v20 row_newbcast:7 row_mask:0xf bank_mask:0xf
    v_and_b32_dpp v29, v18, v21 row_newbcast:7 row_mask:0xf bank_mask:0xf
    v_and_b32_dpp v30, v18, v22 row_newbcast:7 row_mask:0xf bank_mask:0xf
    v_and_b32_dpp v31, v18, v23 row_newbcast:7 row_mask:0xf bank_mask:0xf
    s_cmp_gt_i32 s69, 25
    s_cbranch_scc1 L_h_391
    s_waitcnt vmcnt(5)
L_h_391:
    s_waitcnt vmcnt(7)
    buffer_load_dwordx4 v[100:103], v3, s[40:43], s48 offen offset:256 nt
    s_xor_b32 s48, s48, s12
    v_mfma_f32_16x16x32_bf16 v[12:15], v[24:27], v[244:247], v[12:15]
    v_mfma_f32_16x16x32_bf16 v[8:11], v[28:31], v[248:251], v[8:11]
    v_and_b32_dpp v24, v18, v20 row_newbcast:8 row_mask:0xf bank_mask:0xf
    v_and_b32_dpp v25, v18, v21 row_newbcast:8 row_mask:0xf bank_mask:0xf
    v_and_b32_dpp v26, v18, v22 row_newbcast:8 row_mask:0xf bank_mask:0xf
    v_and_b32_dpp v27, v18, v23 row_newbcast:8 row_mask:0xf bank_mask:0xf
    v_mfma_f32_16x16x32_bf16 v[12:15], v[28:31], v[252:255], v[12:15]
    s_nop 0
    v_mfma_f32_16x16x32_bf16 v[8:11], v[24:27], v[64:67], v[8:11]
    v_and_b32_dpp v28, v18, v20 row_newbcast:9 row_mask:0xf bank_mask:0xf
    v_and_b32_dpp v29, v18, v21 row_newbcast:9 row_mask:0xf bank_mask:0xf
    v_and_b32_dpp v30, v18, v22 row_newbcast:9 row_mask:0xf bank_mask:0xf
    v_and_b32_dpp v31, v18, v23 row_newbcast:9 row_mask:0xf bank_mask:0xf
    v_mfma_f32_16x16x32_bf16 v[12:15], v[24:27], v[68:71], v[12:15]
    s_cmp_gt_i32 s69, 26
    s_cbranch_scc1 L_h_393
    s_waitcnt vmcnt(4)
L_h_393:
    s_waitcnt vmcnt(6)
    buffer_load_dwordx4 v[104:107], v3, s[40:43], s48 offen offset:0 nt
    v_mfma_f32_16x16x32_bf16 v[8:11], v[28:31], v[72:75], v[8:11]
    v_and_b32_dpp v24, v18, v20 row_newbcast:10 row_mask:0xf bank_mask:0xf
    v_and_b32_dpp v25, v18, v21 row_newbcast:10 row_mask:0xf bank_mask:0xf
    v_and_b32_dpp v26, v18, v22 row_newbcast:10 row_mask:0xf bank_mask:0xf
    v_and_b32_dpp v27, v18, v23 row_newbcast:10 row_mask:0xf bank_mask:0xf
    s_cmp_gt_i32 s69, 27
    s_cbranch_scc1 L_h_395
    s_waitcnt vmcnt(4)
L_h_395:
    s_waitcnt vmcnt(5)
    buffer_load_dwordx4 v[108:111], v3, s[40:43], s48 offen offset:256 nt
    s_xor_b32 s48, s48, s13
    v_mfma_f32_16x16x32_bf16 v[12:15], v[28:31], v[76:79], v[12:15]
    s_cmp_gt_i32 s69, 28
    s_cbranch_scc1 L_h_397
    s_waitcnt vmcnt(4)
L_h_397:
    s_waitcnt vmcnt(5)
    buffer_load_dwordx4 v[112:115], v3, s[40:43], s48 offen offset:0 nt
    s_cmp_eq_u32 s66, 0
    s_cbranch_scc1 L_nofb_399
    v_lshl_add_u32 v1, v0, 13, v1
    v_and_b32 v1, 0xffff, v1
    v_subrev_u32 v2, s68, v2
    v_cmp_gt_u32 s[22:23], 64, v2
    s_and_b32 s20, s22, 0x7f
    s_bcnt1_i32_b32 s20, s20
    s_cmp_lt_u32 s72, 2
    s_cselect_b64 s[26:27], s[6:7], s[4:5]
    s_lshl_b32 s20, s20, 3
    s_lshr_b64 s[26:27], s[26:27], s20
    s_sext_i32_i8 s26, s26
    v_mov_b32 v2, 16896
    v_mov_b32 v4, s26
    ds_write_b32 v2, v4 offset:16
L_nofb_399:
    s_add_u32 s68, s68, 1
    s_lshr_b32 s72, s72, 1
    s_bitcmp1_b32 s72, 0
    s_cselect_b32 s66, s71, 0
    s_branch L_brk2_400s
L_brk2_400:
    s_setpc_b64 s[4:5]
L_brk2_400s:
    v_mfma_f32_16x16x32_bf16 v[8:11], v[24:27], v[80:83], v[8:11]
    v_and_b32_dpp v28, v18, v20 row_newbcast:11 row_mask:0xf bank_mask:0xf
    v_and_b32_dpp v29, v18, v21 row_newbcast:11 row_mask:0xf bank_mask:0xf
    v_and_b32_dpp v30, v18, v22 row_newbcast:11 row_mask:0xf bank_mask:0xf
    v_and_b32_dpp v31, v18, v23 row_newbcast:11 row_mask:0xf bank_mask:0xf
    s_cmp_gt_i32 s69, 29
    s_cbranch_scc1 L_h_401
    s_waitcnt vmcnt(4)
L_h_401:
    s_waitcnt vmcnt(5)
    buffer_load_dwordx4 v[116:119], v3, s[40:43], s48 offen offset:256 nt
    s_xor_b32 s48, s48, s12
    v_mfma_f32_16x16x32_bf16 v[12:15], v[24:27], v[84:87], v[12:15]
    s_cmp_gt_i32 s69, 30
    s_cbranch_scc1 L_h_403
    s_waitcnt vmcnt(4)
L_h_403:
    s_waitcnt vmcnt(5)
    buffer_load_dwordx4 v[120:123], v3, s[40:43], s48 offen offset:0 nt
    v_mov_b32 v4, 16896
    v_mov_b32 v2, 1
    s_mov_b64 exec, 1
    ds_add_rtn_u32 v2, v4, v2 offset:20
    s_mov_b64 exec, -1
    ds_read_b32 v4, v4 offset:16
    v_mfma_f32_16x16x32_bf16 v[8:11], v[28:31], v[88:91], v[8:11]
    v_and_b32_dpp v24, v18, v20 row_newbcast:12 row_mask:0xf bank_mask:0xf
    v_and_b32_dpp v25, v18, v21 row_newbcast:12 row_mask:0xf bank_mask:0xf
    v_and_b32_dpp v26, v18, v22 row_newbcast:12 row_mask:0xf bank_mask:0xf
    v_and_b32_dpp v27, v18, v23 row_newbcast:12 row_mask:0xf bank_mask:0xf
    s_cmp_gt_i32 s69, 31
    s_cbranch_scc1 L_h_405
    s_waitcnt vmcnt(4)
L_h_405:
    s_waitcnt vmcnt(5)
    buffer_load_dwordx4 v[124:127], v3, s[40:43], s48 offen offset:256 nt
    s_xor_b32 s48, s48, s17
    s_waitcnt lgkmcnt(0)
    v_readfirstlane_b32 s69, v4
    v_readfirstlane_b32 s20, v2
    s_lshl_b32 s20, s20, 3
    s_lshr_b32 s20, s73, s20
    s_sext_i32_i8 s20, s20
    s_add_i32 s69, s69, s20
    s_sub_i32 s70, 0, s69
    v_mfma_f32_16x16x32_bf16 v[12:15], v[28:31], v[92:95], v[12:15]
    s_cmp_gt_i32 s69, 0
    s_cbranch_scc1 L_h_407
    s_cmp_gt_i32 s70, 0
    s_cbranch_scc0 L_m_408
    s_waitcnt vmcnt(3)
L_m_408:
    s_waitcnt vmcnt(4)
L_h_407:
    s_waitcnt vmcnt(5)
    buffer_load_dwordx4 v[64:67], v3, s[40:43], s48 offen offset:0 nt
    v_mfma_f32_16x16x32_bf16 v[8:11], v[24:27], v[96:99], v[8:11]
    v_and_b32_dpp v28, v18, v20 row_newbcast:13 row_mask:0xf bank_mask:0xf
    v_and_b32_dpp v29, v18, v21 row_newbcast:13 row_mask:0xf bank_mask:0xf
    v_and_b32_dpp v30, v18, v22 row_newbcast:13 row_mask:0xf bank_mask:0xf
    v_and_b32_dpp v31, v18, v23 row_newbcast:13 row_mask:0xf bank_mask:0xf
    s_cmp_gt_i32 s69, 1
    s_cbranch_scc1 L_h_409
    s_cmp_gt_i32 s70, 1
    s_cbranch_scc0 L_m_410
    s_waitcnt vmcnt(3)
L_m_410:
    s_waitcnt vmcnt(4)
L_h_409:
    s_waitcnt vmcnt(5)
    buffer_load_dwordx4 v[68:71], v3, s[40:43], s48 offen offset:256 nt
    s_xor_b32 s48, s48, s12
    v_mfma_f32_16x16x32_bf16 v[12:15], v[24:27], v[100:103], v[12:15]
    s_cmp_gt_i32 s69, 2
    s_cbranch_scc1 L_h_411
    s_cmp_gt_i32 s70, 2
    s_cbranch_scc0 L_m_412
    s_waitcnt vmcnt(3)
L_m_412:
    s_waitcnt vmcnt(4)
L_h_411:
    s_waitcnt vmcnt(5)
    buffer_load_dwordx4 v[72:75], v3, s[40:43], s48 offen offset:0 nt
    v_mfma_f32_16x16x32_bf16 v[8:11], v[28:31], v[104:107], v[8:11]
    v_and_b32_dpp v24, v18, v20 row_newbcast:14 row_mask:0xf bank_mask:0xf
    v_and_b32_dpp v25, v18, v21 row_newbcast:14 row_mask:0xf bank_mask:0xf
    v_and_b32_dpp v26, v18, v22 row_newbcast:14 row_mask:0xf bank_mask:0xf
    v_and_b32_dpp v27, v18, v23 row_newbcast:14 row_mask:0xf bank_mask:0xf
    s_cmp_gt_i32 s69, 3
    s_cbranch_scc1 L_h_413
    s_cmp_gt_i32 s70, 3
    s_cbranch_scc0 L_m_414
    s_waitcnt vmcnt(3)
L_m_414:
    s_waitcnt vmcnt(4)
L_h_413:
    s_waitcnt vmcnt(5)
    buffer_load_dwordx4 v[76:79], v3, s[40:43], s48 offen offset:256 nt
    s_xor_b32 s48, s48, s13
    v_mfma_f32_16x16x32_bf16 v[12:15], v[28:31], v[108:111], v[12:15]
    s_cmp_gt_i32 s69, 4
    s_cbranch_scc1 L_h_415
    s_cmp_gt_i32 s70, 4
    s_cbranch_scc0 L_m_416
    s_waitcnt vmcnt(3)
L_m_416:
    s_waitcnt vmcnt(4)
L_h_415:
    s_waitcnt vmcnt(5)
    buffer_load_dwordx4 v[80:83], v3, s[40:43], s48 offen offset:0 nt
    v_mfma_f32_16x16x32_bf16 v[8:11], v[24:27], v[112:115], v[8:11]
    v_and_b32_dpp v28, v18, v20 row_newbcast:15 row_mask:0xf bank_mask:0xf
    v_and_b32_dpp v29, v18, v21 row_newbcast:15 row_mask:0xf bank_mask:0xf
    v_and_b32_dpp v30, v18, v22 row_newbcast:15 row_mask:0xf bank_mask:0xf
    v_and_b32_dpp v31, v18, v23 row_newbcast:15 row_mask:0xf bank_mask:0xf
    s_cmp_gt_i32 s69, 5
    s_cbranch_scc1 L_h_417
    s_cmp_gt_i32 s70, 5
    s_cbranch_scc0 L_m_418
    s_waitcnt vmcnt(3)
L_m_418:
    s_waitcnt vmcnt(4)
L_h_417:
    s_waitcnt vmcnt(5)
    buffer_load_dwordx4 v[84:87], v3, s[40:43], s48 offen offset:256 nt
    s_xor_b32 s48, s48, s12
    v_mfma_f32_16x16x32_bf16 v[12:15], v[24:27], v[116:119], v[12:15]
    s_cmp_gt_i32 s69, 6
    s_cbranch_scc1 L_h_419
    s_cmp_gt_i32 s70, 6
    s_cbranch_scc0 L_m_420
    s_waitcnt vmcnt(3)
L_m_420:
    s_waitcnt vmcnt(4)
L_h_419:
    s_waitcnt vmcnt(5)
    buffer_load_dwordx4 v[88:91], v3, s[40:43], s48 offen offset:0 nt
    v_mfma_f32_16x16x32_bf16 v[8:11], v[28:31], v[120:123], v[8:11]
    s_waitcnt lgkmcnt(0)
    v_mov_b32 v18, v19
    ds_read_b32 v19, v6 offset:768
    s_nop 0
    v_and_b32_dpp v24, v18, v20 row_newbcast:0 row_mask:0xf bank_mask:0xf
    v_and_b32_dpp v25, v18, v21 row_newbcast:0 row_mask:0xf bank_mask:0xf
    v_and_b32_dpp v26, v18, v22 row_newbcast:0 row_mask:0xf bank_mask:0xf
    v_and_b32_dpp v27, v18, v23 row_newbcast:0 row_mask:0xf bank_mask:0xf
    s_cmp_gt_i32 s69, 7
    s_cbranch_scc1 L_h_421
    s_cmp_gt_i32 s70, 7
    s_cbranch_scc0 L_m_422
    s_waitcnt vmcnt(3)
L_m_422:
    s_waitcnt vmcnt(4)
L_h_421:
    s_waitcnt vmcnt(5)
    buffer_load_dwordx4 v[92:95], v3, s[40:43], s48 offen offset:256 nt
    s_xor_b32 s48, s48, s14
    v_mfma_f32_16x16x32_bf16 v[12:15], v[28:31], v[124:127], v[12:15]
    s_mov_b32 s49, 13
    s_mov_b32 s60, 3
    s_branch L_brk2_424s
.p2align 12
L_brk2_424:
    s_setpc_b64 s[4:5]
L_brk2_424s:
L_st_423:
    s_cmp_gt_i32 s69, 8
    s_cbranch_scc1 L_h_425
    s_cmp_gt_i32 s70, 8
    s_cbranch_scc0 L_m_426
    s_waitcnt vmcnt(3)
L_m_426:
    s_waitcnt vmcnt(4)
L_h_425:
    s_waitcnt vmcnt(5)
    buffer_load_dwordx4 v[96:99], v3, s[40:43], s48 offen offset:0 nt
    v_mfma_f32_16x16x32_bf16 v[8:11], v[24:27], v[64:67], v[8:11]
    v_and_b32_dpp v28, v18, v20 row_newbcast:1 row_mask:0xf bank_mask:0xf
    v_and_b32_dpp v29, v18, v21 row_newbcast:1 row_mask:0xf bank_mask:0xf
    v_and_b32_dpp v30, v18, v22 row_newbcast:1 row_mask:0xf bank_mask:0xf
    v_and_b32_dpp v31, v18, v23 row_newbcast:1 row_mask:0xf bank_mask:0xf
    s_cmp_gt_i32 s69, 9
    s_cbranch_scc1 L_h_427
    s_cmp_gt_i32 s70, 9
    s_cbranch_scc0 L_m_428
    s_waitcnt vmcnt(3)
L_m_428:
    s_waitcnt vmcnt(4)
L_h_427:
    s_waitcnt vmcnt(5)
    buffer_load_dwordx4 v[100:103], v3, s[40:43], s48 offen offset:256 nt
    s_xor_b32 s48, s48, s12
    v_mfma_f32_16x16x32_bf16 v[12:15], v[24:27], v[68:71], v[12:15]
    s_cmp_gt_i32 s69, 10
    s_cbranch_scc1 L_h_429
    s_cmp_gt_i32 s70, 10
    s_cbranch_scc0 L_m_430
    s_waitcnt vmcnt(3)
L_m_430:
    s_waitcnt vmcnt(4)
L_h_429:
    s_waitcnt vmcnt(5)
    buffer_load_dwordx4 v[104:107], v3, s[40:43], s48 offen offset:0 nt
    v_mfma_f32_16x16x32_bf16 v[8:11], v[28:31], v[72:75], v[8:11]
    v_and_b32_dpp v24, v18, v20 row_newbcast:2 row_mask:0xf bank_mask:0xf
    v_and_b32_dpp v25, v18, v21 row_newbcast:2 row_mask:0xf bank_mask:0xf
    v_and_b32_dpp v26, v18, v22 row_newbcast:2 row_mask:0xf bank_mask:0xf
    v_and_b32_dpp v27, v18, v23 row_newbcast:2 row_mask:0xf bank_mask:0xf
    s_cmp_gt_i32 s69, 11
    s_cbranch_scc1 L_h_431
    s_cmp_gt_i32 s70, 11
    s_cbranch_scc0 L_m_432
    s_waitcnt vmcnt(3)
L_m_432:
    s_waitcnt vmcnt(4)
L_h_431:
    s_waitcnt vmcnt(5)
    buffer_load_dwordx4 v[108:111], v3, s[40:43], s48 offen offset:256 nt
    s_xor_b32 s48, s48, s13
    v_mfma_f32_16x16x32_bf16 v[12:15], v[28:31], v[76:79], v[12:15]
    s_cmp_gt_i32 s69, 12
    s_cbranch_scc1 L_h_433
    s_cmp_gt_i32 s70, 12
    s_cbranch_scc0 L_m_434
    s_waitcnt vmcnt(3)
L_m_434:
    s_waitcnt vmcnt(4)
L_h_433:
    s_waitcnt vmcnt(5)
    buffer_load_dwordx4 v[112:115], v3, s[40:43], s48 offen offset:0 nt
    v_mfma_f32_16x16x32_bf16 v[8:11], v[24:27], v[80:83], v[8:11]
    v_and_b32_dpp v28, v18, v20 row_newbcast:3 row_mask:0xf bank_mask:0xf
    v_and_b32_dpp v29, v18, v21 row_newbcast:3 row_mask:0xf bank_mask:0xf
    v_and_b32_dpp v30, v18, v22 row_newbcast:3 row_mask:0xf bank_mask:0xf
    v_and_b32_dpp v31, v18, v23 row_newbcast:3 row_mask:0xf bank_mask:0xf
    s_cmp_gt_i32 s69, 13
    s_cbranch_scc1 L_h_435
    s_cmp_gt_i32 s70, 13
    s_cbranch_scc0 L_m_436
    s_waitcnt vmcnt(3)
L_m_436:
    s_waitcnt vmcnt(4)
L_h_435:
    s_waitcnt vmcnt(5)
    buffer_load_dwordx4 v[116:119], v3, s[40:43], s48 offen offset:256 nt
    s_xor_b32 s48, s48, s12
    v_mfma_f32_16x16x32_bf16 v[12:15], v[24:27], v[84:87], v[12:15]
    s_cmp_gt_i32 s69, 14
    s_cbranch_scc1 L_h_437
    s_cmp_gt_i32 s70, 14
    s_cbranch_scc0 L_m_438
    s_waitcnt vmcnt(3)
L_m_438:
    s_waitcnt vmcnt(4)
L_h_437:
    s_waitcnt vmcnt(5)
    buffer_load_dwordx4 v[120:123], v3, s[40:43], s48 offen offset:0 nt
    v_mfma_f32_16x16x32_bf16 v[8:11], v[28:31], v[88:91], v[8:11]
    v_and_b32_dpp v24, v18, v20 row_newbcast:4 row_mask:0xf bank_mask:0xf
    v_and_b32_dpp v25, v18, v21 row_newbcast:4 row_mask:0xf bank_mask:0xf
    v_and_b32_dpp v26, v18, v22 row_newbcast:4 row_mask:0xf bank_mask:0xf
    v_and_b32_dpp v27, v18, v23 row_newbcast:4 row_mask:0xf bank_mask:0xf
    s_cmp_gt_i32 s69, 15
    s_cbranch_scc1 L_h_439
    s_cmp_gt_i32 s70, 15
    s_cbranch_scc0 L_m_440
    s_waitcnt vmcnt(3)
L_m_440:
    s_waitcnt vmcnt(4)
L_h_439:
    s_waitcnt vmcnt(5)
    buffer_load_dwordx4 v[124:127], v3, s[40:43], s48 offen offset:256 nt
    s_xor_b32 s48, s48, s15
    v_mfma_f32_16x16x32_bf16 v[12:15], v[28:31], v[92:95], v[12:15]
    s_cmp_gt_i32 s69, 16
    s_cbranch_scc1 L_h_441
    s_waitcnt vmcnt(4)
L_h_441:
    s_waitcnt vmcnt(5)
    buffer_load_dwordx4 v[64:67], v3, s[40:43], s48 offen offset:0 nt
    v_mfma_f32_16x16x32_bf16 v[8:11], v[24:27], v[96:99], v[8:11]
    v_and_b32_dpp v28, v18, v20 row_newbcast:5 row_mask:0xf bank_mask:0xf
    v_and_b32_dpp v29, v18, v21 row_newbcast:5 row_mask:0xf bank_mask:0xf
    v_and_b32_dpp v30, v18, v22 row_newbcast:5 row_mask:0xf bank_mask:0xf
    v_and_b32_dpp v31, v18, v23 row_newbcast:5 row_mask:0xf bank_mask:0xf
    s_cmp_gt_i32 s69, 17
    s_cbranch_scc1 L_h_443
    s_waitcnt vmcnt(4)
L_h_443:
    s_waitcnt vmcnt(5)
    buffer_load_dwordx4 v[68:71], v3, s[40:43], s48 offen offset:256 nt
    s_xor_b32 s48, s48, s12
    v_mfma_f32_16x16x32_bf16 v[12:15], v[24:27], v[100:103], v[12:15]
    s_cmp_gt_i32 s69, 18
    s_cbranch_scc1 L_h_445
    s_waitcnt vmcnt(4)
L_h_445:
    s_waitcnt vmcnt(5)
    buffer_load_dwordx4 v[72:75], v3, s[40:43], s48 offen offset:0 nt
    v_mfma_f32_16x16x32_bf16 v[8:11], v[28:31], v[104:107], v[8:11]
    v_and_b32_dpp v24, v18, v20 row_newbcast:6 row_mask:0xf bank_mask:0xf
    v_and_b32_dpp v25, v18, v21 row_newbcast:6 row_mask:0xf bank_mask:0xf
    v_and_b32_dpp v26, v18, v22 row_newbcast:6 row_mask:0xf bank_mask:0xf
    v_and_b32_dpp v27, v18, v23 row_newbcast:6 row_mask:0xf bank_mask:0xf
    s_cmp_gt_i32 s69, 19
    s_cbranch_scc1 L_h_447
    s_waitcnt vmcnt(4)
L_h_447:
    s_waitcnt vmcnt(5)
    buffer_load_dwordx4 v[76:79], v3, s[40:43], s48 offen offset:256 nt
    s_xor_b32 s48, s48, s13
    v_mov_b32 v4, s68
    s_mov_b64 exec, 1
    buffer_store_dword v4, off, s[64:67], s63 sc1
    s_mov_b64 exec, -1
    v_mfma_f32_16x16x32_bf16 v[12:15], v[28:31], v[108:111], v[12:15]
    s_cmp_gt_i32 s69, 20
    s_cbranch_scc1 L_h_449
    s_waitcnt vmcnt(5)
L_h_449:
    s_waitcnt vmcnt(6)
    buffer_load_dwordx4 v[80:83], v3, s[40:43], s48 offen offset:0 nt
    s_mov_b64 exec, 0x7f
    buffer_load_dword v2, v1, s[64:67], 0 offen sc1
    s_mov_b64 exec, -1
    v_mfma_f32_16x16x32_bf16 v[8:11], v[24:27], v[112:115], v[8:11]
    v_and_b32_dpp v28, v18, v20 row_newbcast:7 row_mask:0xf bank_mask:0xf
    v_and_b32_dpp v29, v18, v21 row_newbcast:7 row_mask:0xf bank_mask:0xf
    v_and_b32_dpp v30, v18, v22 row_newbcast:7 row_mask:0xf bank_mask:0xf
    v_and_b32_dpp v31, v18, v23 row_newbcast:7 row_mask:0xf bank_mask:0xf
    s_cmp_gt_i32 s69, 21
    s_cbranch_scc1 L_h_451
    s_waitcnt vmcnt(6)
L_h_451:
    s_waitcnt vmcnt(7)
    buffer_load_dwordx4 v[84:87], v3, s[40:43], s48 offen offset:256 nt
    s_xor_b32 s48, s48, s12
    v_mfma_f32_16x16x32_bf16 v[12:15], v[24:27], v[116:119], v[12:15]
    s_cmp_gt_i32 s69, 22
    s_cbranch_scc1 L_h_453
    s_waitcnt vmcnt(6)
L_h_453:
    s_waitcnt vmcnt(7)
    buffer_load_dwordx4 v[88:91], v3, s[40:43], s48 offen offset:0 nt
    v_mfma_f32_16x16x32_bf16 v[8:11], v[28:31], v[120:123], v[8:11]
    v_and_b32_dpp v24, v18, v20 row_newbcast:8 row_mask:0xf bank_mask:0xf
    v_and_b32_dpp v25, v18, v21 row_newbcast:8 row_mask:0xf bank_mask:0xf
    v_and_b32_dpp v26, v18, v22 row_newbcast:8 row_mask:0xf bank_mask:0xf
    v_and_b32_dpp v27, v18, v23 row_newbcast:8 row_mask:0xf bank_mask:0xf
    s_cmp_gt_i32 s69, 23
    s_cbranch_scc1 L_h_455
    s_waitcnt vmcnt(6)
L_h_455:
    s_waitcnt vmcnt(7)
    buffer_load_dwordx4 v[92:95], v3, s[40:43], s48 offen offset:256 nt
    s_xor_b32 s48, s48, s14
    v_mfma_f32_16x16x32_bf16 v[12:15], v[28:31], v[124:127], v[12:15]
    s_cmp_gt_i32 s69, 24
    s_cbranch_scc1 L_h_457
    s_waitcnt vmcnt(6)
L_h_457:
    s_waitcnt vmcnt(7)
    buffer_load_dwordx4 v[96:99], v3, s[40:43], s48 offen offset:0 nt
    v_mfma_f32_16x16x32_bf16 v[8:11], v[24:27], v[64:67], v[8:11]
    v_and_b32_dpp v28, v18, v20 row_newbcast:9 row_mask:0xf bank_mask:0xf
    v_and_b32_dpp v29, v18, v21 row_newbcast:9 row_mask:0xf bank_mask:0xf
    v_and_b32_dpp v30, v18, v22 row_newbcast:9 row_mask:0xf bank_mask:0xf
    v_and_b32_dpp v31, v18, v23 row_newbcast:9 row_mask:0xf bank_mask:0xf
    s_cmp_gt_i32 s69, 25
    s_cbranch_scc1 L_h_459
    s_waitcnt vmcnt(5)
L_h_459:
    s_waitcnt vmcnt(7)
    buffer_load_dwordx4 v[100:103], v3, s[40:43], s48 offen offset:256 nt
    s_xor_b32 s48, s48, s12
    v_mfma_f32_16x16x32_bf16 v[12:15], v[24:27], v[68:71], v[12:15]
    s_cmp_gt_i32 s69, 26
    s_cbranch_scc1 L_h_461
    s_waitcnt vmcnt(4)
L_h_461:
    s_waitcnt vmcnt(6)
    buffer_load_dwordx4 v[104:107], v3, s[40:43], s48 offen offset:0 nt
    v_mfma_f32_16x16x32_bf16 v[8:11], v[28:31], v[72:75], v[8:11]
    v_and_b32_dpp v24, v18, v20 row_newbcast:10 row_mask:0xf bank_mask:0xf
    v_and_b32_dpp v25, v18, v21 row_newbcast:10 row_mask:0xf bank_mask:0xf
    v_and_b32_dpp v26, v18, v22 row_newbcast:10 row_mask:0xf bank_mask:0xf
    v_and_b32_dpp v27, v18, v23 row_newbcast:10 row_mask:0xf bank_mask:0xf
    s_cmp_gt_i32 s69, 27
    s_cbranch_scc1 L_h_463
    s_waitcnt vmcnt(4)
L_h_463:
    s_waitcnt vmcnt(5)
    buffer_load_dwordx4 v[108:111], v3, s[40:43], s48 offen offset:256 nt
    s_xor_b32 s48, s48, s13
    v_mfma_f32_16x16x32_bf16 v[12:15], v[28:31], v[76:79], v[12:15]
    s_cmp_gt_i32 s69, 28
    s_cbranch_scc1 L_h_465
    s_waitcnt vmcnt(4)
L_h_465:
    s_waitcnt vmcnt(5)
    buffer_load_dwordx4 v[112:115], v3, s[40:43], s48 offen offset:0 nt
    s_cmp_eq_u32 s66, 0
    s_cbranch_scc1 L_nofb_467
    v_lshl_add_u32 v1, v0, 13, v1
    v_and_b32 v1, 0xffff, v1
    v_subrev_u32 v2, s68, v2
    v_cmp_gt_u32 s[22:23], 64, v2
    s_and_b32 s20, s22, 0x7f
    s_bcnt1_i32_b32 s20, s20
    s_cmp_lt_u32 s72, 2
    s_cselect_b64 s[26:27], s[6:7], s[4:5]
    s_lshl_b32 s20, s20, 3
    s_lshr_b64 s[26:27], s[26:27], s20
    s_sext_i32_i8 s26, s26
    v_mov_b32 v2, 16896
    v_mov_b32 v4, s26
    ds_write_b32 v2, v4 offset:16
L_nofb_467:
    s_add_u32 s68, s68, 1
    s_lshr_b32 s72, s72, 1
    s_bitcmp1_b32 s72, 0
    s_cselect_b32 s66, s71, 0
    v_mfma_f32_16x16x32_bf16 v[8:11], v[24:27], v[80:83], v[8:11]
    v_and_b32_dpp v28, v18, v20 row_newbcast:11 row_mask:0xf bank_mask:0xf
    v_and_b32_dpp v29, v18, v21 row_newbcast:11 row_mask:0xf bank_mask:0xf
    v_and_b32_dpp v30, v18, v22 row_newbcast:11 row_mask:0xf bank_mask:0xf
    v_and_b32_dpp v31, v18, v23 row_newbcast:11 row_mask:0xf bank_mask:0xf
    s_cmp_gt_i32 s69, 29
    s_cbranch_scc1 L_h_468
    s_waitcnt vmcnt(4)
L_h_468:
    s_waitcnt vmcnt(5)
    buffer_load_dwordx4 v[116:119], v3, s[40:43], s48 offen offset:256 nt
    s_xor_b32 s48, s48, s12
    v_mfma_f32_16x16x32_bf16 v[12:15], v[24:27], v[84:87], v[12:15]
    s_cmp_gt_i32 s69, 30
    s_cbranch_scc1 L_h_470
    s_waitcnt vmcnt(4)
L_h_470:
    s_waitcnt vmcnt(5)
    buffer_load_dwordx4 v[120:123], v3, s[40:43], s48 offen offset:0 nt
    v_mov_b32 v4, 16896
    v_mov_b32 v2, 1
    s_mov_b64 exec, 1
    ds_add_rtn_u32 v2, v4, v2 offset:20
    s_mov_b64 exec, -1
    ds_read_b32 v4, v4 offset:16
    v_mfma_f32_16x16x32_bf16 v[8:11], v[28:31], v[88:91], v[8:11]
    v_and_b32_dpp v24, v18, v20 row_newbcast:12 row_mask:0xf bank_mask:0xf
    v_and_b32_dpp v25, v18, v21 row_newbcast:12 row_mask:0xf bank_mask:0xf
    v_and_b32_dpp v26, v18, v22 row_newbcast:12 row_mask:0xf bank_mask:0xf
    v_and_b32_dpp v27, v18, v23 row_newbcast:12 row_mask:0xf bank_mask:0xf
    s_cmp_gt_i32 s69, 31
    s_cbranch_scc1 L_h_472
    s_waitcnt vmcnt(4)
L_h_472:
    s_waitcnt vmcnt(5)
    buffer_load_dwordx4 v[124:127], v3, s[40:43], s48 offen offset:256 nt
    s_ff1_i32_b32 s20, s60
    s_add_u32 s60, s60, 1
    s_cmp_eq_u32 s20, 2
    s_cselect_b32 s21, s18, s19
    s_cmp_eq_u32 s20, 1
    s_cselect_b32 s21, s17, s21
    s_cmp_eq_u32 s20, 0
    s_cselect_b32 s21, s16, s21
    s_xor_b32 s48, s48, s21
    s_waitcnt lgkmcnt(0)
    v_readfirstlane_b32 s69, v4
    v_readfirstlane_b32 s20, v2
    s_lshl_b32 s20, s20, 3
    s_lshr_b32 s20, s73, s20
    s_sext_i32_i8 s20, s20
    s_add_i32 s69, s69, s20
    s_sub_i32 s70, 0, s69
    v_mfma_f32_16x16x32_bf16 v[12:15], v[28:31], v[92:95], v[12:15]
    s_cmp_gt_i32 s69, 0
    s_cbranch_scc1 L_h_474
    s_cmp_gt_i32 s70, 0
    s_cbranch_scc0 L_m_475
    s_waitcnt vmcnt(3)
L_m_475:
    s_waitcnt vmcnt(4)
L_h_474:
    s_waitcnt vmcnt(5)
    buffer_load_dwordx4 v[64:67], v3, s[40:43], s48 offen offset:0 nt
    v_mfma_f32_16x16x32_bf16 v[8:11], v[24:27], v[96:99], v[8:11]
    v_and_b32_dpp v28, v18, v20 row_newbcast:13 row_mask:0xf bank_mask:0xf
    v_and_b32_dpp v29, v18, v21 row_newbcast:13 row_mask:0xf bank_mask:0xf
    v_and_b32_dpp v30, v18, v22 row_newbcast:13 row_mask:0xf bank_mask:0xf
    v_and_b32_dpp v31, v18, v23 row_newbcast:13 row_mask:0xf bank_mask:0xf
    s_cmp_gt_i32 s69, 1
    s_cbranch_scc1 L_h_476
    s_cmp_gt_i32 s70, 1
    s_cbranch_scc0 L_m_477
    s_waitcnt vmcnt(3)
L_m_477:
    s_waitcnt vmcnt(4)
L_h_476:
    s_waitcnt vmcnt(5)
    buffer_load_dwordx4 v[68:71], v3, s[40:43], s48 offen offset:256 nt
    s_xor_b32 s48, s48, s12
    v_mfma_f32_16x16x32_bf16 v[12:15], v[24:27], v[100:103], v[12:15]
    s_cmp_gt_i32 s69, 2
    s_cbranch_scc1 L_h_478
    s_cmp_gt_i32 s70, 2
    s_cbranch_scc0 L_m_479
    s_waitcnt vmcnt(3)
L_m_479:
    s_waitcnt vmcnt(4)
L_h_478:
    s_waitcnt vmcnt(5)
    buffer_load_dwordx4 v[72:75], v3, s[40:43], s48 offen offset:0 nt
    v_mfma_f32_16x16x32_bf16 v[8:11], v[28:31], v[104:107], v[8:11]
    v_and_b32_dpp v24, v18, v20 row_newbcast:14 row_mask:0xf bank_mask:0xf
    v_and_b32_dpp v25, v18, v21 row_newbcast:14 row_mask:0xf bank_mask:0xf
    v_and_b32_dpp v26, v18, v22 row_newbcast:14 row_mask:0xf bank_mask:0xf
    v_and_b32_dpp v27, v18, v23 row_newbcast:14 row_mask:0xf bank_mask:0xf
    s_cmp_gt_i32 s69, 3
    s_cbranch_scc1 L_h_480
    s_cmp_gt_i32 s70, 3
    s_cbranch_scc0 L_m_481
    s_waitcnt vmcnt(3)
L_m_481:
    s_waitcnt vmcnt(4)
L_h_480:
    s_waitcnt vmcnt(5)
    buffer_load_dwordx4 v[76:79], v3, s[40:43], s48 offen offset:256 nt
    s_xor_b32 s48, s48, s13
    v_mfma_f32_16x16x32_bf16 v[12:15], v[28:31], v[108:111], v[12:15]
    s_cmp_gt_i32 s69, 4
    s_cbranch_scc1 L_h_482
    s_cmp_gt_i32 s70, 4
    s_cbranch_scc0 L_m_483
    s_waitcnt vmcnt(3)
L_m_483:
    s_waitcnt vmcnt(4)
L_h_482:
    s_waitcnt vmcnt(5)
    buffer_load_dwordx4 v[80:83], v3, s[40:43], s48 offen offset:0 nt
    v_mfma_f32_16x16x32_bf16 v[8:11], v[24:27], v[112:115], v[8:11]
    v_and_b32_dpp v28, v18, v20 row_newbcast:15 row_mask:0xf bank_mask:0xf
    v_and_b32_dpp v29, v18, v21 row_newbcast:15 row_mask:0xf bank_mask:0xf
    v_and_b32_dpp v30, v18, v22 row_newbcast:15 row_mask:0xf bank_mask:0xf
    v_and_b32_dpp v31, v18, v23 row_newbcast:15 row_mask:0xf bank_mask:0xf
    s_cmp_gt_i32 s69, 5
    s_cbranch_scc1 L_h_484
    s_cmp_gt_i32 s70, 5
    s_cbranch_scc0 L_m_485
    s_waitcnt vmcnt(3)
L_m_485:
    s_waitcnt vmcnt(4)
L_h_484:
    s_waitcnt vmcnt(5)
    buffer_load_dwordx4 v[84:87], v3, s[40:43], s48 offen offset:256 nt
    s_xor_b32 s48, s48, s12
    v_mfma_f32_16x16x32_bf16 v[12:15], v[24:27], v[116:119], v[12:15]
    s_cmp_gt_i32 s69, 6
    s_cbranch_scc1 L_h_486
    s_cmp_gt_i32 s70, 6
    s_cbranch_scc0 L_m_487
    s_waitcnt vmcnt(3)
L_m_487:
    s_waitcnt vmcnt(4)
L_h_486:
    s_waitcnt vmcnt(5)
    buffer_load_dwordx4 v[88:91], v3, s[40:43], s48 offen offset:0 nt
    v_mfma_f32_16x16x32_bf16 v[8:11], v[28:31], v[120:123], v[8:11]
    s_waitcnt lgkmcnt(0)
    v_mov_b32 v18, v19
    ds_read_b32 v19, v6 offset:1024
    s_nop 0
    v_and_b32_dpp v24, v18, v20 row_newbcast:0 row_mask:0xf bank_mask:0xf
    v_and_b32_dpp v25, v18, v21 row_newbcast:0 row_mask:0xf bank_mask:0xf
    v_and_b32_dpp v26, v18, v22 row_newbcast:0 row_mask:0xf bank_mask:0xf
    v_and_b32_dpp v27, v18, v23 row_newbcast:0 row_mask:0xf bank_mask:0xf
    s_cmp_gt_i32 s69, 7
    s_cbranch_scc1 L_h_488
    s_cmp_gt_i32 s70, 7
    s_cbranch_scc0 L_m_489
    s_waitcnt vmcnt(3)
L_m_489:
    s_waitcnt vmcnt(4)
L_h_488:
    s_waitcnt vmcnt(5)
    buffer_load_dwordx4 v[92:95], v3, s[40:43], s48 offen offset:256 nt
    s_xor_b32 s48, s48, s14
    v_mfma_f32_16x16x32_bf16 v[12:15], v[28:31], v[124:127], v[12:15]
    v_add_u32 v6, 0x100, v6
    s_sub_u32 s49, s49, 1
    s_cmp_lg_u32 s49, 0
    s_cbranch_scc1 L_st_423
    s_lshl_b32 s49, s34, 10
    v_and_b32 v32, 15, v0
    v_lshlrev_b32 v32, 5, v32
    v_and_b32 v33, 48, v0
    v_add3_u32 v48, v32, v33, s49
    v_lshlrev_b32 v7, 4, v0
    v_mov_b32 v5, 16896
    v_mov_b32 v17, 1
    s_mul_i32 s49, s2, 1024
    s_add_u32 s49, s49, 0x280000
    s_branch L_brk2_490s
L_brk2_490:
    s_setpc_b64 s[4:5]
L_brk2_490s:
    s_cmp_gt_i32 s69, 8
    s_cbranch_scc1 L_h_491
    s_cmp_gt_i32 s70, 8
    s_cbranch_scc0 L_m_492
    s_waitcnt vmcnt(3)
L_m_492:
    s_waitcnt vmcnt(4)
L_h_491:
    s_waitcnt vmcnt(5)
    buffer_load_dwordx4 v[96:99], v3, s[40:43], s48 offen offset:0 nt
    v_mfma_f32_16x16x32_bf16 v[8:11], v[24:27], v[64:67], v[8:11]
    v_and_b32_dpp v28, v18, v20 row_newbcast:1 row_mask:0xf bank_mask:0xf
    v_and_b32_dpp v29, v18, v21 row_newbcast:1 row_mask:0xf bank_mask:0xf
    v_and_b32_dpp v30, v18, v22 row_newbcast:1 row_mask:0xf bank_mask:0xf
    v_and_b32_dpp v31, v18, v23 row_newbcast:1 row_mask:0xf bank_mask:0xf
    v_mfma_f32_16x16x32_bf16 v[12:15], v[24:27], v[68:71], v[12:15]
    s_cmp_gt_i32 s69, 9
    s_cbranch_scc1 L_h_493
    s_cmp_gt_i32 s70, 9
    s_cbranch_scc0 L_m_494
    s_waitcnt vmcnt(3)
L_m_494:
    s_waitcnt vmcnt(4)
L_h_493:
    s_waitcnt vmcnt(5)
    buffer_load_dwordx4 v[100:103], v3, s[40:43], s48 offen offset:256 nt
    s_xor_b32 s48, s48, s12
    v_mfma_f32_16x16x32_bf16 v[8:11], v[28:31], v[72:75], v[8:11]
    v_and_b32_dpp v24, v18, v20 row_newbcast:2 row_mask:0xf bank_mask:0xf
    v_and_b32_dpp v25, v18, v21 row_newbcast:2 row_mask:0xf bank_mask:0xf
    v_and_b32_dpp v26, v18, v22 row_newbcast:2 row_mask:0xf bank_mask:0xf
    v_and_b32_dpp v27, v18, v23 row_newbcast:2 row_mask:0xf bank_mask:0xf
    v_mfma_f32_16x16x32_bf16 v[12:15], v[28:31], v[76:79], v[12:15]
    s_cmp_gt_i32 s69, 10
    s_cbranch_scc1 L_h_495
    s_cmp_gt_i32 s70, 10
    s_cbranch_scc0 L_m_496
    s_waitcnt vmcnt(3)
L_m_496:
    s_waitcnt vmcnt(4)
L_h_495:
    s_waitcnt vmcnt(5)
    buffer_load_dwordx4 v[104:107], v3, s[40:43], s48 offen offset:0 nt
    v_mfma_f32_16x16x32_bf16 v[8:11], v[24:27], v[80:83], v[8:11]
    v_and_b32_dpp v28, v18, v20 row_newbcast:3 row_mask:0xf bank_mask:0xf
    v_and_b32_dpp v29, v18, v21 row_newbcast:3 row_mask:0xf bank_mask:0xf
    v_and_b32_dpp v30, v18, v22 row_newbcast:3 row_mask:0xf bank_mask:0xf
    v_and_b32_dpp v31, v18, v23 row_newbcast:3 row_mask:0xf bank_mask:0xf
    s_cmp_gt_i32 s69, 11
    s_cbranch_scc1 L_h_497
    s_cmp_gt_i32 s70, 11
    s_cbranch_scc0 L_m_498
    s_waitcnt vmcnt(3)
L_m_498:
    s_waitcnt vmcnt(4)
L_h_497:
    s_waitcnt vmcnt(5)
    buffer_load_dwordx4 v[108:111], v3, s[40:43], s48 offen offset:256 nt
    s_xor_b32 s48, s48, s13
    v_mfma_f32_16x16x32_bf16 v[12:15], v[24:27], v[84:87], v[12:15]
    s_cmp_gt_i32 s69, 12
    s_cbranch_scc1 L_h_499
    s_cmp_gt_i32 s70, 12
    s_cbranch_scc0 L_m_500
    s_waitcnt vmcnt(3)
L_m_500:
    s_waitcnt vmcnt(4)
L_h_499:
    s_waitcnt vmcnt(5)
    buffer_load_dwordx4 v[112:115], v3, s[40:43], s48 offen offset:0 nt
    v_mfma_f32_16x16x32_bf16 v[8:11], v[28:31], v[88:91], v[8:11]
    v_and_b32_dpp v24, v18, v20 row_newbcast:4 row_mask:0xf bank_mask:0xf
    v_and_b32_dpp v25, v18, v21 row_newbcast:4 row_mask:0xf bank_mask:0xf
    v_and_b32_dpp v26, v18, v22 row_newbcast:4 row_mask:0xf bank_mask:0xf
    v_and_b32_dpp v27, v18, v23 row_newbcast:4 row_mask:0xf bank_mask:0xf
    s_cmp_gt_i32 s69, 13
    s_cbranch_scc1 L_h_501
    s_cmp_gt_i32 s70, 13
    s_cbranch_scc0 L_m_502
    s_waitcnt vmcnt(3)
L_m_502:
    s_waitcnt vmcnt(4)
L_h_501:
    s_waitcnt vmcnt(5)
    buffer_load_dwordx4 v[116:119], v3, s[40:43], s48 offen offset:256 nt
    s_xor_b32 s48, s48, s12
    v_mfma_f32_16x16x32_bf16 v[12:15], v[28:31], v[92:95], v[12:15]
    s_cmp_gt_i32 s69, 14
    s_cbranch_scc1 L_h_503
    s_cmp_gt_i32 s70, 14
    s_cbranch_scc0 L_m_504
    s_waitcnt vmcnt(3)
L_m_504:
    s_waitcnt vmcnt(4)
L_h_503:
    s_waitcnt vmcnt(5)
    buffer_load_dwordx4 v[120:123], v3, s[40:43], s48 offen offset:0 nt
    v_mfma_f32_16x16x32_bf16 v[8:11], v[24:27], v[96:99], v[8:11]
    v_and_b32_dpp v28, v18, v20 row_newbcast:5 row_mask:0xf bank_mask:0xf
    v_and_b32_dpp v29, v18, v21 row_newbcast:5 row_mask:0xf bank_mask:0xf
    v_and_b32_dpp v30, v18, v22 row_newbcast:5 row_mask:0xf bank_mask:0xf
    v_and_b32_dpp v31, v18, v23 row_newbcast:5 row_mask:0xf bank_mask:0xf
    s_cmp_gt_i32 s69, 15
    s_cbranch_scc1 L_h_505
    s_cmp_gt_i32 s70, 15
    s_cbranch_scc0 L_m_506
    s_waitcnt vmcnt(3)
L_m_506:
    s_waitcnt vmcnt(4)
L_h_505:
    s_waitcnt vmcnt(5)
    buffer_load_dwordx4 v[124:127], v3, s[40:43], s48 offen offset:256 nt
    s_xor_b32 s48, s48, s15
    v_mfma_f32_16x16x32_bf16 v[12:15], v[24:27], v[100:103], v[12:15]
    s_cmp_gt_i32 s69, 16
    s_cbranch_scc1 L_h_507
    s_waitcnt vmcnt(4)
L_h_507:
    s_waitcnt vmcnt(5)
    buffer_load_dwordx4 v[64:67], v3, s[40:43], s48 offen offset:0 nt
    v_mfma_f32_16x16x32_bf16 v[8:11], v[28:31], v[104:107], v[8:11]
    v_and_b32_dpp v24, v18, v20 row_newbcast:6 row_mask:0xf bank_mask:0xf
    v_and_b32_dpp v25, v18, v21 row_newbcast:6 row_mask:0xf bank_mask:0xf
    v_and_b32_dpp v26, v18, v22 row_newbcast:6 row_mask:0xf bank_mask:0xf
    v_and_b32_dpp v27, v18, v23 row_newbcast:6 row_mask:0xf bank_mask:0xf
    s_cmp_gt_i32 s69, 17
    s_cbranch_scc1 L_h_509
    s_waitcnt vmcnt(4)
L_h_509:
    s_waitcnt vmcnt(5)
    buffer_load_dwordx4 v[68:71], v3, s[40:43], s48 offen offset:256 nt
    s_xor_b32 s48, s48, s12
    v_mfma_f32_16x16x32_bf16 v[12:15], v[28:31], v[108:111], v[12:15]
    s_cmp_gt_i32 s69, 18
    s_cbranch_scc1 L_h_511
    s_waitcnt vmcnt(4)
L_h_511:
    s_waitcnt vmcnt(5)
    buffer_load_dwordx4 v[72:75], v3, s[40:43], s48 offen offset:0 nt
    v_mfma_f32_16x16x32_bf16 v[8:11], v[24:27], v[112:115], v[8:11]
    v_and_b32_dpp v28, v18, v20 row_newbcast:7 row_mask:0xf bank_mask:0xf
    v_and_b32_dpp v29, v18, v21 row_newbcast:7 row_mask:0xf bank_mask:0xf
    v_and_b32_dpp v30, v18, v22 row_newbcast:7 row_mask:0xf bank_mask:0xf
    v_and_b32_dpp v31, v18, v23 row_newbcast:7 row_mask:0xf bank_mask:0xf
    s_cmp_gt_i32 s69, 19
    s_cbranch_scc1 L_h_513
    s_waitcnt vmcnt(4)
L_h_513:
    s_waitcnt vmcnt(5)
    buffer_load_dwordx4 v[76:79], v3, s[40:43], s48 offen offset:256 nt
    s_xor_b32 s48, s48, s13
    v_mfma_f32_16x16x32_bf16 v[12:15], v[24:27], v[116:119], v[12:15]
    s_cmp_gt_i32 s69, 20
    s_cbranch_scc1 L_h_515
    s_waitcnt vmcnt(4)
L_h_515:
    s_waitcnt vmcnt(5)
    buffer_load_dwordx4 v[80:83], v3, s[40:43], s48 offen offset:0 nt
    v_mfma_f32_16x16x32_bf16 v[8:11], v[28:31], v[120:123], v[8:11]
    v_and_b32_dpp v24, v18, v20 row_newbcast:8 row_mask:0xf bank_mask:0xf
    v_and_b32_dpp v25, v18, v21 row_newbcast:8 row_mask:0xf bank_mask:0xf
    v_and_b32_dpp v26, v18, v22 row_newbcast:8 row_mask:0xf bank_mask:0xf
    v_and_b32_dpp v27, v18, v23 row_newbcast:8 row_mask:0xf bank_mask:0xf
    s_cmp_gt_i32 s69, 21
    s_cbranch_scc1 L_h_517
    s_waitcnt vmcnt(4)
L_h_517:
    s_waitcnt vmcnt(5)
    buffer_load_dwordx4 v[84:87], v3, s[40:43], s48 offen offset:256 nt
    s_xor_b32 s48, s48, s12
    v_mfma_f32_16x16x32_bf16 v[12:15], v[28:31], v[124:127], v[12:15]
    s_cmp_gt_i32 s69, 22
    s_cbranch_scc1 L_h_519
    s_waitcnt vmcnt(4)
L_h_519:
    s_waitcnt vmcnt(5)
    buffer_load_dwordx4 v[88:91], v3, s[40:43], s48 offen offset:0 nt
    v_mfma_f32_16x16x32_bf16 v[8:11], v[24:27], v[64:67], v[8:11]
    v_and_b32_dpp v28, v18, v20 row_newbcast:9 row_mask:0xf bank_mask:0xf
    v_and_b32_dpp v29, v18, v21 row_newbcast:9 row_mask:0xf bank_mask:0xf
    v_and_b32_dpp v30, v18, v22 row_newbcast:9 row_mask:0xf bank_mask:0xf
    v_and_b32_dpp v31, v18, v23 row_newbcast:9 row_mask:0xf bank_mask:0xf
    s_cmp_gt_i32 s69, 23
    s_cbranch_scc1 L_h_521
    s_waitcnt vmcnt(4)
L_h_521:
    s_waitcnt vmcnt(5)
    buffer_load_dwordx4 v[92:95], v3, s[40:43], s48 offen offset:256 nt
    s_xor_b32 s48, s48, s14
    v_mfma_f32_16x16x32_bf16 v[12:15], v[24:27], v[68:71], v[12:15]
    s_cmp_gt_i32 s69, 24
    s_cbranch_scc1 L_h_523
    s_waitcnt vmcnt(4)
L_h_523:
    s_waitcnt vmcnt(5)
    buffer_load_dwordx4 v[96:99], v3, s[40:43], s48 offen offset:0 nt
    v_mfma_f32_16x16x32_bf16 v[8:11], v[28:31], v[72:75], v[8:11]
    v_and_b32_dpp v24, v18, v20 row_newbcast:10 row_mask:0xf bank_mask:0xf
    v_and_b32_dpp v25, v18, v21 row_newbcast:10 row_mask:0xf bank_mask:0xf
    v_and_b32_dpp v26, v18, v22 row_newbcast:10 row_mask:0xf bank_mask:0xf
    v_and_b32_dpp v27, v18, v23 row_newbcast:10 row_mask:0xf bank_mask:0xf
    s_cmp_gt_i32 s69, 25
    s_cbranch_scc1 L_h_525
    s_waitcnt vmcnt(4)
L_h_525:
    s_waitcnt vmcnt(5)
    buffer_load_dwordx4 v[100:103], v3, s[40:43], s48 offen offset:256 nt
    s_xor_b32 s48, s48, s12
    v_mfma_f32_16x16x32_bf16 v[12:15], v[28:31], v[76:79], v[12:15]
    s_cmp_gt_i32 s69, 26
    s_cbranch_scc1 L_h_527
    s_waitcnt vmcnt(4)
L_h_527:
    s_waitcnt vmcnt(5)
    buffer_load_dwordx4 v[104:107], v3, s[40:43], s48 offen offset:0 nt
    v_mfma_f32_16x16x32_bf16 v[8:11], v[24:27], v[80:83], v[8:11]
    v_and_b32_dpp v28, v18, v20 row_newbcast:11 row_mask:0xf bank_mask:0xf
    v_and_b32_dpp v29, v18, v21 row_newbcast:11 row_mask:0xf bank_mask:0xf
    v_and_b32_dpp v30, v18, v22 row_newbcast:11 row_mask:0xf bank_mask:0xf
    v_and_b32_dpp v31, v18, v23 row_newbcast:11 row_mask:0xf bank_mask:0xf
    s_cmp_gt_i32 s69, 27
    s_cbranch_scc1 L_h_529
    s_waitcnt vmcnt(4)
L_h_529:
    s_waitcnt vmcnt(5)
    buffer_load_dwordx4 v[108:111], v3, s[40:43], s48 offen offset:256 nt
    s_xor_b32 s48, s48, s13
    v_mfma_f32_16x16x32_bf16 v[12:15], v[24:27], v[84:87], v[12:15]
    s_cmp_gt_i32 s69, 28
    s_cbranch_scc1 L_h_531
    s_waitcnt vmcnt(4)
L_h_531:
    s_waitcnt vmcnt(5)
    buffer_load_dwordx4 v[112:115], v3, s[40:43], s48 offen offset:0 nt
    v_mfma_f32_16x16x32_bf16 v[8:11], v[28:31], v[88:91], v[8:11]
    v_and_b32_dpp v24, v18, v20 row_newbcast:12 row_mask:0xf bank_mask:0xf
    v_and_b32_dpp v25, v18, v21 row_newbcast:12 row_mask:0xf bank_mask:0xf
    v_and_b32_dpp v26, v18, v22 row_newbcast:12 row_mask:0xf bank_mask:0xf
    v_and_b32_dpp v27, v18, v23 row_newbcast:12 row_mask:0xf bank_mask:0xf
    s_cmp_gt_i32 s69, 29
    s_cbranch_scc1 L_h_533
    s_waitcnt vmcnt(4)
L_h_533:
    s_waitcnt vmcnt(5)
    buffer_load_dwordx4 v[116:119], v3, s[40:43], s48 offen offset:256 nt
    s_xor_b32 s48, s48, s12
    v_mfma_f32_16x16x32_bf16 v[12:15], v[28:31], v[92:95], v[12:15]
    s_cmp_gt_i32 s69, 30
    s_cbranch_scc1 L_h_535
    s_waitcnt vmcnt(4)
L_h_535:
    s_waitcnt vmcnt(5)
    buffer_load_dwordx4 v[120:123], v3, s[40:43], s48 offen offset:0 nt
    v_mfma_f32_16x16x32_bf16 v[8:11], v[24:27], v[96:99], v[8:11]
    v_and_b32_dpp v28, v18, v20 row_newbcast:13 row_mask:0xf bank_mask:0xf
    v_and_b32_dpp v29, v18, v21 row_newbcast:13 row_mask:0xf bank_mask:0xf
    v_and_b32_dpp v30, v18, v22 row_newbcast:13 row_mask:0xf bank_mask:0xf
    v_and_b32_dpp v31, v18, v23 row_newbcast:13 row_mask:0xf bank_mask:0xf
    s_cmp_gt_i32 s69, 31
    s_cbranch_scc1 L_h_537
    s_waitcnt vmcnt(4)
L_h_537:
    s_waitcnt vmcnt(5)
    buffer_load_dwordx4 v[124:127], v3, s[40:43], s48 offen offset:256 nt
    s_barrier
    v_mfma_f32_16x16x32_bf16 v[12:15], v[24:27], v[100:103], v[12:15]
    s_waitcnt vmcnt(5)
    v_mfma_f32_16x16x32_bf16 v[8:11], v[28:31], v[104:107], v[8:11]
    v_and_b32_dpp v24, v18, v20 row_newbcast:14 row_mask:0xf bank_mask:0xf
    v_and_b32_dpp v25, v18, v21 row_newbcast:14 row_mask:0xf bank_mask:0xf
    v_and_b32_dpp v26, v18, v22 row_newbcast:14 row_mask:0xf bank_mask:0xf
    v_and_b32_dpp v27, v18, v23 row_newbcast:14 row_mask:0xf bank_mask:0xf
    s_waitcnt vmcnt(4)
    v_mfma_f32_16x16x32_bf16 v[12:15], v[28:31], v[108:111], v[12:15]
    s_waitcnt vmcnt(3)
    v_mfma_f32_16x16x32_bf16 v[8:11], v[24:27], v[112:115], v[8:11]
    v_and_b32_dpp v28, v18, v20 row_newbcast:15 row_mask:0xf bank_mask:0xf
    v_and_b32_dpp v29, v18, v21 row_newbcast:15 row_mask:0xf bank_mask:0xf
    v_and_b32_dpp v30, v18, v22 row_newbcast:15 row_mask:0xf bank_mask:0xf
    v_and_b32_dpp v31, v18, v23 row_newbcast:15 row_mask:0xf bank_mask:0xf
    s_waitcnt vmcnt(2)
    v_mfma_f32_16x16x32_bf16 v[12:15], v[24:27], v[116:119], v[12:15]
    s_waitcnt vmcnt(1)
    v_mfma_f32_16x16x32_bf16 v[8:11], v[28:31], v[120:123], v[8:11]
    s_waitcnt vmcnt(0)
    v_mfma_f32_16x16x32_bf16 v[12:15], v[28:31], v[124:127], v[12:15]
    s_mov_b32 exec_hi, 0
    s_nop 4
    ds_write_b128 v48, v[8:11] offset:17408
    s_nop 0
    ds_write_b128 v48, v[12:15] offset:17920
    s_mov_b64 exec, 1
    ds_add_rtn_u32 v16, v5, v17 offset:12
    s_mov_b64 exec, -1
    s_waitcnt lgkmcnt(0)
    v_readfirstlane_b32 s48, v16
    s_cmp_lg_u32 s48, 3
    s_cbranch_scc1 L_stream_done
    ds_read_b128 v[32:35], v7 offset:17408
    ds_read_b128 v[36:39], v7 offset:18432
    ds_read_b128 v[40:43], v7 offset:19456
    ds_read_b128 v[44:47], v7 offset:20480
    s_waitcnt lgkmcnt(0)
    v_pk_add_f32 v[32:33], v[32:33], v[36:37]
    v_pk_add_f32 v[40:41], v[40:41], v[44:45]
    v_pk_add_f32 v[34:35], v[34:35], v[38:39]
    v_pk_add_f32 v[42:43], v[42:43], v[46:47]
    v_pk_add_f32 v[32:33], v[32:33], v[40:41]
    v_pk_add_f32 v[34:35], v[34:35], v[42:43]
    v_min_u32 v32, -2, v32
    v_min_u32 v33, -2, v33
    v_min_u32 v34, -2, v34
    v_min_u32 v35, -2, v35
    buffer_store_dwordx4 v[32:35], v7, s[44:47], s49 offen sc1
L_stream_done:
    s_endpgm
.p2align 12
L_brk0_539:
L_brk0_539s:
L_wslow:
L_common:
    s_mov_b32 s44, s28
    s_mov_b32 s45, s29
    s_mov_b32 s46, 0x400000
    s_mov_b32 s47, 0x20000
    s_and_b32 s56, s30, 3
    s_lshr_b32 s57, s30, 2
    s_mul_i32 s58, s57, 2
    s_add_u32 s58, s58, s56
    s_sub_u32 s58, s58, 2
    s_mul_i32 s58, s58, 14
    s_lshr_b32 s59, s31, 1
    s_add_u32 s58, s58, s59
    s_cmp_lt_u32 s59, 14
    s_cselect_b32 s58, s58, 63
    s_mul_i32 s33, s58, 37
    s_lshr_b32 s33, s33, 8
    s_mul_i32 s59, s33, 7
    s_sub_u32 s98, s58, s59
    s_lshl_b32 s33, s33, 1
    s_and_b32 s32, s31, 1
    s_cmp_lt_u32 s58, 56
    s_cselect_b32 s97, 1, 0
    s_mul_i32 s58, s56, 28
    s_add_u32 s58, s58, s31
    s_cmp_lt_u32 s31, 28
    s_cselect_b32 s59, 2, 0
    s_cmp_lt_u32 s56, 2
    s_cselect_b32 s97, s59, s97
    s_cselect_b32 s98, s58, s98
    s_cselect_b32 s32, s57, s32
    s_mov_b32 s52, s4
    s_mov_b32 s53, s5
    s_mov_b32 s54, 0x700
    s_mov_b32 s55, 0x20000
    s_mov_b32 s68, s24
    s_mov_b32 s69, s25
    s_mov_b32 s70, 0x700
    s_mov_b32 s71, 0x20000
    s_mov_b32 s64, s18
    s_mov_b32 s65, s19
    s_mov_b32 s66, 0x188000
    s_mov_b32 s67, 0x20000
    s_cmp_eq_u32 s97, 2
    s_cselect_b32 s60, s16, s12
    s_cselect_b32 s61, s17, s13
    s_mov_b32 s56, 1605632
    s_cselect_b32 s62, s56, 3670016
    s_mov_b32 s63, 0x20000
    v_mov_b32 v46, 16896
    v_mov_b32 v47, 1
    s_cmp_eq_u32 s3, 0
    s_cbranch_scc1 L_norole
    s_lshl_b32 s56, s34, 9
    v_lshl_add_u32 v50, v0, 3, s56
    v_bfe_u32 v10, v0, 1, 1
    v_lshlrev_b32 v10, 8, v10
    v_lshl_add_u32 v10, v9, 4, v10
    v_add_u32 v51, s56, v10
    s_lshl_b32 s56, s34, 10
    s_add_u32 s56, s56, 21504
    v_and_b32 v10, 3, v0
    v_lshlrev_b32 v10, 5, v10
    v_lshl_add_u32 v10, v1, 8, v10
    v_add_u32 v44, s56, v10
    v_lshlrev_b32 v10, 4, v2
    v_lshl_add_u32 v45, v1, 10, v10
    v_bfe_u32 v10, v0, 3, 1
    v_lshlrev_b32 v10, 14, v10
    v_lshl_add_u32 v10, v1, 15, v10
    v_lshl_add_u32 v48, v11, 4, v10
    v_lshlrev_b32 v10, 14, v3
    v_lshl_add_u32 v49, v4, 4, v10
    s_cmp_eq_u32 s3, 3
    s_cbranch_scc1 L_perm
    s_waitcnt vmcnt(8)
    v_and_b32 v27, 0xffff0000, v13
    v_lshlrev_b32 v26, 16, v13
    v_and_b32 v25, 0xffff0000, v12
    v_lshlrev_b32 v24, 16, v12
    v_mul_f32 v28, 0xbfb8aa3b, v24
    v_mul_f32 v29, 0xbfb8aa3b, v25
    v_mul_f32 v30, 0xbfb8aa3b, v26
    v_mul_f32 v31, 0xbfb8aa3b, v27
    v_exp_f32 v28, v28
    v_exp_f32 v29, v29
    v_exp_f32 v30, v30
    v_exp_f32 v31, v31
    v_add_f32 v28, 1.0, v28
    v_add_f32 v29, 1.0, v29
    v_add_f32 v30, 1.0, v30
    v_add_f32 v31, 1.0, v31
    v_rcp_f32 v28, v28
    v_rcp_f32 v29, v29
    v_rcp_f32 v30, v30
    v_rcp_f32 v31, v31
    v_mul_f32 v24, v24, v28
    v_mul_f32 v25, v25, v29
    v_mul_f32 v26, v26, v30
    v_mul_f32 v27, v27, v31
    v_cvt_pk_bf16_f32 v12, v24, v25
    v_cvt_pk_bf16_f32 v13, v26, v27
    ds_write_b64 v50, v[12:13] offset:25600
    ds_read_b128 v[160:163], v51 offset:25600
    s_cmp_lg_u32 s3, 4
    s_cbranch_scc1 L_perm
    v_lshlrev_b32 v24, 16, v14
    v_and_b32 v25, 0xffff0000, v14
    v_lshlrev_b32 v26, 16, v15
    v_and_b32 v27, 0xffff0000, v15
    v_lshlrev_b32 v28, 16, v16
    v_and_b32 v29, 0xffff0000, v16
    v_lshlrev_b32 v30, 16, v17
    v_and_b32 v31, 0xffff0000, v17
    v_lshlrev_b32 v32, 16, v18
    v_and_b32 v33, 0xffff0000, v18
    v_lshlrev_b32 v34, 16, v19
    v_and_b32 v35, 0xffff0000, v19
    v_lshlrev_b32 v36, 16, v20
    v_and_b32 v37, 0xffff0000, v20
    v_add_f32 v38, v24, v25
    v_add_f32 v40, v26, v27
    v_add_f32 v38, v38, v28
    v_add_f32 v40, v40, v29
    v_add_f32 v38, v38, v30
    v_add_f32 v40, v40, v31
    v_add_f32 v38, v38, v32
    v_add_f32 v40, v40, v33
    v_add_f32 v38, v38, v34
    v_add_f32 v40, v40, v35
    v_add_f32 v38, v38, v36
    v_add_f32 v40, v40, v37
    v_add_f32 v38, v38, v40
    s_nop 1
    v_add_f32_dpp v38, v38, v38 row_ror:8 row_mask:0xf bank_mask:0xf
    s_nop 1
    v_add_f32_dpp v38, v38, v38 row_ror:4 row_mask:0xf bank_mask:0xf
    s_nop 1
    v_add_f32_dpp v38, v38, v38 row_ror:2 row_mask:0xf bank_mask:0xf
    s_nop 1
    v_add_f32_dpp v38, v38, v38 row_ror:1 row_mask:0xf bank_mask:0xf
    v_mov_b32 v40, v38
    s_nop 1
    v_permlane16_swap_b32 v38, v40
    v_add_f32 v38, v38, v40
    v_mul_f32 v39, 0x3b124925, v38
    v_fmamk_f32 v40, v39, 0xc3e00000, v38
    v_fmac_f32 v39, 0x3b124925, v40
    v_sub_f32 v24, v24, v39
    v_sub_f32 v25, v25, v39
    v_sub_f32 v26, v26, v39
    v_sub_f32 v27, v27, v39
    v_sub_f32 v28, v28, v39
    v_sub_f32 v29, v29, v39
    v_sub_f32 v30, v30, v39
    v_sub_f32 v31, v31, v39
    v_sub_f32 v32, v32, v39
    v_sub_f32 v33, v33, v39
    v_sub_f32 v34, v34, v39
    v_sub_f32 v35, v35, v39
    v_sub_f32 v36, v36, v39
    v_sub_f32 v37, v37, v39
    v_mul_f32 v38, v24, v24
    v_mul_f32 v40, v25, v25
    v_fmac_f32 v38, v26, v26
    v_fmac_f32 v40, v27, v27
    v_fmac_f32 v38, v28, v28
    v_fmac_f32 v40, v29, v29
    v_fmac_f32 v38, v30, v30
    v_fmac_f32 v40, v31, v31
    v_fmac_f32 v38, v32, v32
    v_fmac_f32 v40, v33, v33
    v_fmac_f32 v38, v34, v34
    v_fmac_f32 v40, v35, v35
    v_fmac_f32 v38, v36, v36
    v_fmac_f32 v40, v37, v37
    v_add_f32 v38, v38, v40
    s_nop 1
    v_add_f32_dpp v38, v38, v38 row_ror:8 row_mask:0xf bank_mask:0xf
    s_nop 1
    v_add_f32_dpp v38, v38, v38 row_ror:4 row_mask:0xf bank_mask:0xf
    s_nop 1
    v_add_f32_dpp v38, v38, v38 row_ror:2 row_mask:0xf bank_mask:0xf
    s_nop 1
    v_add_f32_dpp v38, v38, v38 row_ror:1 row_mask:0xf bank_mask:0xf
    v_mov_b32 v40, v38
    s_nop 1
    v_permlane16_swap_b32 v38, v40
    v_add_f32 v38, v38, v40
    v_mul_f32 v41, 0x3b124925, v38
    v_fmamk_f32 v40, v41, 0xc3e00000, v38
    v_fmac_f32 v41, 0x3b124925, v40
    v_cvt_pk_bf16_f32 v40, v39, v41
    v_lshlrev_b32 v39, 16, v40
    v_and_b32 v41, 0xffff0000, v40
    v_add_f32 v41, 0x3727c5ac, v41
    v_cvt_pk_bf16_f32 v41, v41, v41
    v_and_b32 v41, 0xffff0000, v41
    v_sqrt_f32 v41, v41
    s_nop 0
    v_cvt_pk_bf16_f32 v41, v41, v41
    v_and_b32 v41, 0xffff0000, v41
    v_rcp_f32 v41, v41
    v_mov_b32 v38, v39
    v_mov_b32 v40, v41
    s_mov_b32 vcc_lo, 0xff00ff00
    s_mov_b32 vcc_hi, 0xff00ff00
    v_permlane32_swap_b32 v39, v38
    v_permlane32_swap_b32 v41, v40
    v_cndmask_b32 v39, v39, v38, vcc
    v_cndmask_b32 v41, v41, v40, vcc
    v_and_b32 v55, 0xffff0000, v23
    v_lshlrev_b32 v54, 16, v23
    v_and_b32 v53, 0xffff0000, v22
    v_lshlrev_b32 v52, 16, v22
    v_sub_f32 v52, v52, v39
    v_sub_f32 v53, v53, v39
    v_sub_f32 v54, v54, v39
    v_sub_f32 v55, v55, v39
    v_cvt_pk_bf16_f32 v28, v52, v53
    v_lshlrev_b32 v52, 16, v28
    v_and_b32 v53, 0xffff0000, v28
    v_cvt_pk_bf16_f32 v29, v54, v55
    v_lshlrev_b32 v54, 16, v29
    v_and_b32 v55, 0xffff0000, v29
    v_mul_f32 v52, v52, v41
    v_mul_f32 v53, v53, v41
    v_mul_f32 v54, v54, v41
    v_mul_f32 v55, v55, v41
    v_cvt_pk_bf16_f32 v28, v52, v53
    v_lshlrev_b32 v52, 16, v28
    v_and_b32 v53, 0xffff0000, v28
    v_cvt_pk_bf16_f32 v29, v54, v55
    v_lshlrev_b32 v54, 16, v29
    v_and_b32 v55, 0xffff0000, v29
L_brk0_540:
L_brk0_540s:
L_perm:
    s_waitcnt vmcnt(6)
    v_perm_b32 v96, v68, v64, s72
    v_perm_b32 v100, v68, v64, s73
    v_perm_b32 v104, v69, v65, s72
    v_perm_b32 v108, v69, v65, s73
    v_perm_b32 v112, v70, v66, s72
    v_perm_b32 v116, v70, v66, s73
    v_perm_b32 v120, v71, v67, s72
    v_perm_b32 v124, v71, v67, s73
    s_waitcnt vmcnt(4)
    v_perm_b32 v97, v76, v72, s72
    v_perm_b32 v101, v76, v72, s73
    v_perm_b32 v105, v77, v73, s72
    v_perm_b32 v109, v77, v73, s73
    v_perm_b32 v113, v78, v74, s72
    v_perm_b32 v117, v78, v74, s73
    v_perm_b32 v121, v79, v75, s72
    v_perm_b32 v125, v79, v75, s73
    s_waitcnt vmcnt(2)
    v_perm_b32 v98, v84, v80, s72
    v_perm_b32 v102, v84, v80, s73
    v_perm_b32 v106, v85, v81, s72
    v_perm_b32 v110, v85, v81, s73
    v_perm_b32 v114, v86, v82, s72
    v_perm_b32 v118, v86, v82, s73
    v_perm_b32 v122, v87, v83, s72
    v_perm_b32 v126, v87, v83, s73
    s_waitcnt vmcnt(0)
    v_perm_b32 v99, v92, v88, s72
    v_perm_b32 v103, v92, v88, s73
    v_perm_b32 v107, v93, v89, s72
    v_perm_b32 v111, v93, v89, s73
    v_perm_b32 v115, v94, v90, s72
    v_perm_b32 v119, v94, v90, s73
    v_perm_b32 v123, v95, v91, s72
    v_perm_b32 v127, v95, v91, s73
    s_waitcnt lgkmcnt(0)
    s_mul_i32 s101, s100, 0x9e3779b1
    s_add_u32 s101, s101, 0x7f4a7c15
    s_cmp_lg_u32 s3, 3
    s_cbranch_scc1 L_mfma
    s_sub_u32 s56, s31, 12
    s_and_b32 s56, s56, 0
    s_lshl_b32 s56, s56, 15
    s_lshl_b32 s57, s34, 9
    s_add_u32 s58, s56, s57
    v_mov_b32 v32, 0
    v_mov_b32 v34, 0
    v_mov_b32 v36, 0
    v_mov_b32 v38, 0
    s_mov_b32 exec_lo, s99
    s_mov_b32 exec_hi, s99
    s_barrier
    buffer_load_dwordx4 v[32:35], v49, s[44:47], s58 offen
    buffer_load_dwordx4 v[36:39], v49, s[44:47], s58 offen offset:1792
L_tp_541:
    s_waitcnt vmcnt(0)
    v_cmp_ne_u32 s[4:5], s101, v33
    v_cmp_ne_u32 s[6:7], s101, v35
    v_cmp_ne_u32 s[8:9], s101, v37
    v_cmp_ne_u32 s[10:11], s101, v39
    s_or_b64 vcc, s[4:5], s[10:11]
    s_or_b64 vcc, vcc, s[6:7]
    s_or_b64 vcc, vcc, s[8:9]
    s_cbranch_scc0 L_tpd_542
    s_sleep 8
    buffer_load_dwordx4 v[32:35], v49, s[44:47], s58 offen sc1
    buffer_load_dwordx4 v[36:39], v49, s[44:47], s58 offen offset:1792 sc1
    s_sub_u32 s74, s74, 1
    s_cmp_gt_i32 s74, 0
    s_cbranch_scc1 L_tp_541
    s_waitcnt vmcnt(0)
L_tpd_542:
    s_mov_b64 exec, -1
    v_and_b32 v27, 0xffff0000, v34
    v_lshlrev_b32 v26, 16, v34
    v_and_b32 v25, 0xffff0000, v32
    v_lshlrev_b32 v24, 16, v32
    v_and_b32 v31, 0xffff0000, v38
    v_lshlrev_b32 v30, 16, v38
    v_and_b32 v29, 0xffff0000, v36
    v_lshlrev_b32 v28, 16, v36
    v_add_f32 v24, v24, v28
    v_add_f32 v25, v25, v29
    v_add_f32 v26, v26, v30
    v_add_f32 v27, v27, v31
    v_cvt_pk_bf16_f32 v12, v24, v25
    v_cvt_pk_bf16_f32 v13, v26, v27
    ds_write_b64 v50, v[12:13] offset:25600
    ds_read_b128 v[160:163], v51 offset:25600
    s_waitcnt lgkmcnt(0)
L_mfma:
    v_mfma_f32_16x16x32_bf16 v[128:131], v[160:163], v[96:99], 0
    v_mfma_f32_16x16x32_bf16 v[132:135], v[160:163], v[100:103], 0
    v_mfma_f32_16x16x32_bf16 v[136:139], v[160:163], v[104:107], 0
    v_mfma_f32_16x16x32_bf16 v[140:143], v[160:163], v[108:111], 0
    v_mfma_f32_16x16x32_bf16 v[144:147], v[160:163], v[112:115], 0
    v_mfma_f32_16x16x32_bf16 v[148:151], v[160:163], v[116:119], 0
    v_mfma_f32_16x16x32_bf16 v[152:155], v[160:163], v[120:123], 0
    v_mfma_f32_16x16x32_bf16 v[156:159], v[160:163], v[124:127], 0
    s_lshl_b32 s58, s35, 7
    s_lshl_b32 s59, s34, 17
    s_add_u32 s58, s58, s59
    s_cmp_eq_u32 s3, 3
    s_cselect_b32 s59, 0x80000, 0
    s_add_u32 s58, s58, s59
    s_mov_b32 exec_lo, 0x00f0000f
    s_mov_b32 exec_hi, 0xf0000f00
    ds_write2_b32 v44, v128, v130 offset0:0 offset1:32
    ds_write2_b32 v44, v132, v134 offset0:1 offset1:33
    ds_write2_b32 v44, v136, v138 offset0:2 offset1:34
    ds_write2_b32 v44, v140, v142 offset0:3 offset1:35
    ds_write2_b32 v44, v144, v146 offset0:4 offset1:36
    ds_write2_b32 v44, v148, v150 offset0:5 offset1:37
    ds_write2_b32 v44, v152, v154 offset0:6 offset1:38
    ds_write2_b32 v44, v156, v158 offset0:7 offset1:39
    s_mov_b64 exec, 1
    ds_add_u32 v46, v47
    s_mov_b64 exec, -1
    s_cmp_lg_u32 s34, 0
    s_cbranch_scc1 L_getq
L_sy_543:
    ds_read_b32 v32, v46 offset:0
    s_waitcnt lgkmcnt(0)
    v_readfirstlane_b32 s56, v32
    s_cmp_ge_u32 s56, 4
    s_cbranch_scc1 L_syd_544
    s_sub_u32 s74, s74, 1
    s_cmp_gt_i32 s74, 0
    s_cbranch_scc1 L_sy_543
L_syd_544:
    ds_read_b128 v[24:27], v45 offset:21504
    ds_read_b128 v[28:31], v45 offset:21760
    ds_read_b128 v[32:35], v45 offset:22016
    ds_read_b128 v[36:39], v45 offset:22272
    s_waitcnt lgkmcnt(0)
    v_add_f32 v24, v24, v28
    v_add_f32 v32, v32, v36
    v_add_f32 v25, v25, v29
    v_add_f32 v33, v33, v37
    v_add_f32 v26, v26, v30
    v_add_f32 v34, v34, v38
    v_add_f32 v27, v27, v31
    v_add_f32 v35, v35, v39
    v_add_f32 v24, v24, v32
    v_add_f32 v25, v25, v33
    v_add_f32 v26, v26, v34
    v_add_f32 v27, v27, v35
    v_mov_b32 v28, v24
    v_mov_b32 v29, v25
    v_mov_b32 v30, v26
    v_mov_b32 v31, v27
    v_permlane16_swap_b32 v24, v28
    v_permlane16_swap_b32 v25, v29
    v_permlane16_swap_b32 v26, v30
    v_permlane16_swap_b32 v27, v31
    v_add_f32 v24, v24, v28
    v_add_f32 v25, v25, v29
    v_add_f32 v26, v26, v30
    v_add_f32 v27, v27, v31
    v_mov_b32 v28, v24
    v_mov_b32 v29, v25
    v_mov_b32 v30, v26
    v_mov_b32 v31, v27
    v_permlane32_swap_b32 v24, v28
    v_permlane32_swap_b32 v25, v29
    v_permlane32_swap_b32 v26, v30
    v_permlane32_swap_b32 v27, v31
    v_add_f32 v24, v24, v28
    v_add_f32 v25, v25, v29
    v_add_f32 v26, v26, v30
    v_add_f32 v27, v27, v31
    s_cmp_lg_u32 s3, 4
    s_cbranch_scc1 L_pub
    v_cvt_pk_bf16_f32 v28, v24, v25
    v_lshlrev_b32 v24, 16, v28
    v_and_b32 v25, 0xffff0000, v28
    v_cvt_pk_bf16_f32 v29, v26, v27
    v_lshlrev_b32 v26, 16, v29
    v_and_b32 v27, 0xffff0000, v29
    v_add_f32 v24, 1.0, v24
    v_add_f32 v25, 1.0, v25
    v_add_f32 v26, 1.0, v26
    v_add_f32 v27, 1.0, v27
    v_cvt_pk_bf16_f32 v28, v24, v25
    v_lshlrev_b32 v24, 16, v28
    v_and_b32 v25, 0xffff0000, v28
    v_cvt_pk_bf16_f32 v29, v26, v27
    v_lshlrev_b32 v26, 16, v29
    v_and_b32 v27, 0xffff0000, v29
    v_mul_f32 v24, v24, v52
    v_mul_f32 v25, v25, v53
    v_mul_f32 v26, v26, v54
    v_mul_f32 v27, v27, v55
L_pub:
    v_cvt_pk_bf16_f32 v24, v24, v25
    v_cvt_pk_bf16_f32 v26, v26, v27
    v_mov_b32 v25, s101
    v_mov_b32 v27, s101
    s_mov_b64 exec, 0xffff
    buffer_store_dwordx4 v[24:27], v48, s[44:47], s58 offen sc1
    s_mov_b64 exec, -1
    s_branch L_getq
L_norole:
    s_waitcnt lgkmcnt(0)
    s_mul_i32 s101, s100, 0x9e3779b1
    s_add_u32 s101, s101, 0x7f4a7c15
L_getq:
    s_cmp_eq_u32 s3, 3
    s_cbranch_scc1 L_mark1
    s_barrier
L_mark1:
    s_mul_i32 s56, s32, 131072
    s_mul_i32 s57, s98, 2048
    s_add_u32 s56, s56, s57
    s_mul_i32 s57, s34, 768
    s_add_u32 s56, s56, s57
    s_add_u32 s58, s56, 0x13fd00
    s_cmp_eq_u32 s97, 2
    s_cselect_b32 s58, s58, 0x400000
    s_mul_i32 s56, s33, 1024
    s_lshl_b32 s57, s32, 17
    s_add_u32 s56, s56, s57
    s_lshl_b32 s57, s98, 8
    s_add_u32 s56, s56, s57
    s_add_u32 s56, s56, 0x100000
    s_cmp_eq_u32 s97, 1
    s_cselect_b32 s56, s56, 0x400000
    s_cmp_eq_u32 s34, 3
    s_cselect_b32 s58, s56, s58
    s_cselect_b32 s59, 17, 8
    s_cselect_b32 s75, 0, 3
    s_mul_i32 s56, s2, 1024
    s_add_u32 s56, s56, 0x280000
    s_cmp_eq_u32 s34, 0
    s_cselect_b32 s58, s56, s58
    v_and_b32 v10, s75, v1
    v_lshlrev_b32 v10, s59, v10
    v_lshl_add_u32 v10, v2, 4, v10
    v_add_u32 v10, s58, v10
    v_mov_b32 v56, -1
    v_mov_b32 v57, -1
    v_mov_b32 v58, -1
    v_mov_b32 v59, -1
    v_mov_b32 v60, v10
    s_barrier
    buffer_store_dwordx4 v[56:59], v60, s[44:47], 0 offen sc1
    s_cmp_lg_u32 s34, 0
    s_cbranch_scc1 L_qdone
    s_lshl_b32 s58, s31, 10
    s_add_u32 s58, s58, 0x80000
    v_lshlrev_b32 v11, 4, v0
    v_lshlrev_b32 v10, 3, v0
    s_waitcnt vmcnt(0)
    buffer_load_dwordx4 v[36:39], v11, s[44:47], s58 offen sc1
L_tp_545:
    s_waitcnt vmcnt(0)
    v_cmp_ne_u32 s[4:5], s101, v37
    v_cmp_ne_u32 s[6:7], s101, v39
    s_or_b64 vcc, s[4:5], s[6:7]
    s_cbranch_scc0 L_tpd_546
    s_sleep 8
    buffer_load_dwordx4 v[36:39], v11, s[44:47], s58 offen sc1
    s_sub_u32 s74, s74, 1
    s_cmp_gt_i32 s74, 0
    s_cbranch_scc1 L_tp_545
    s_waitcnt vmcnt(0)
L_tpd_546:
    v_mov_b32 v37, v38
    ds_write_b64 v10, v[36:37] offset:16384
L_qdone:
    s_cmp_lg_u32 s34, 1
    s_cbranch_scc1 L_walk1_0
    s_call_b64 s[4:5], L_brk1_94
L_walk1_0:
    s_cmp_lg_u32 s34, 2
    s_cbranch_scc1 L_walk1_1
    s_call_b64 s[4:5], L_brk1_121
L_walk1_1:
    s_cmp_lg_u32 s34, 3
    s_cbranch_scc1 L_walk1_2
    s_call_b64 s[4:5], L_brk1_131
L_walk1_2:
    s_waitcnt vmcnt(0) lgkmcnt(0)
    s_setprio 0
    s_barrier
    s_cmp_lg_u32 s34, 0
    s_cbranch_scc1 L_walk2_0
    s_call_b64 s[4:5], L_brk2_1
    s_call_b64 s[4:5], L_brk2_221
    s_call_b64 s[4:5], L_brk2_363
    s_call_b64 s[4:5], L_brk2_490
    s_call_b64 s[4:5], L_brk2_571
L_walk2_0:
    s_cmp_lg_u32 s34, 1
    s_cbranch_scc1 L_walk2_1
    s_call_b64 s[4:5], L_brk2_19
    s_call_b64 s[4:5], L_brk2_287
    s_call_b64 s[4:5], L_brk2_390
    s_call_b64 s[4:5], L_brk2_552
    s_call_b64 s[4:5], L_brk2_574
L_walk2_1:
    s_cmp_lg_u32 s34, 2
    s_cbranch_scc1 L_walk2_2
    s_call_b64 s[4:5], L_brk2_85
    s_call_b64 s[4:5], L_brk2_288
    s_call_b64 s[4:5], L_brk2_400
    s_call_b64 s[4:5], L_brk2_557
    s_call_b64 s[4:5], L_brk2_581
L_walk2_2:
    s_cmp_lg_u32 s34, 3
    s_cbranch_scc1 L_walk2_3
    s_call_b64 s[4:5], L_brk2_155
    s_call_b64 s[4:5], L_brk2_354
    s_call_b64 s[4:5], L_brk2_424
    s_call_b64 s[4:5], L_brk2_562
L_walk2_3:
L_brk0_547:
L_brk0_547s:
    s_lshl_b32 s56, s34, 12
    v_lshl_add_u32 v8, v0, 4, s56
    v_and_b32 v9, 7, v0
    v_lshlrev_b32 v9, 4, v9
    s_lshl_b32 s56, s34, 3
    v_mov_b32 v10, s56
    v_lshlrev_b32 v11, 3, v1
    s_mul_i32 s75, s31, 4352
    s_add_u32 s75, s75, 0x90000
    s_lshl_b32 s59, s30, 4
    s_add_u32 s59, s59, s75
    s_barrier
    ds_read_b128 v[64:67], v8 offset:0
    ds_read_b128 v[68:71], v8 offset:1024
    ds_read_b128 v[72:75], v8 offset:2048
    ds_read_b128 v[76:79], v8 offset:3072
    s_waitcnt lgkmcnt(0)
    v_cvt_pk_bf16_f32 v34, v64, v65
    v_lshlrev_b32 v64, 16, v34
    v_and_b32 v65, 0xffff0000, v34
    v_cvt_pk_bf16_f32 v35, v66, v67
    v_lshlrev_b32 v66, 16, v35
    v_and_b32 v67, 0xffff0000, v35
    v_cvt_pk_bf16_f32 v34, v68, v69
    v_lshlrev_b32 v68, 16, v34
    v_and_b32 v69, 0xffff0000, v34
    v_cvt_pk_bf16_f32 v35, v70, v71
    v_lshlrev_b32 v70, 16, v35
    v_and_b32 v71, 0xffff0000, v35
    v_cvt_pk_bf16_f32 v34, v72, v73
    v_lshlrev_b32 v72, 16, v34
    v_and_b32 v73, 0xffff0000, v34
    v_cvt_pk_bf16_f32 v35, v74, v75
    v_lshlrev_b32 v74, 16, v35
    v_and_b32 v75, 0xffff0000, v35
    v_cvt_pk_bf16_f32 v34, v76, v77
    v_lshlrev_b32 v76, 16, v34
    v_and_b32 v77, 0xffff0000, v34
    v_cvt_pk_bf16_f32 v35, v78, v79
    v_lshlrev_b32 v78, 16, v35
    v_and_b32 v79, 0xffff0000, v35
    v_max3_f32 v32, v64, v65, v66
    v_max3_f32 v34, v67, v68, v69
    v_max3_f32 v32, v32, v70, v71
    v_max3_f32 v34, v34, v72, v73
    v_max3_f32 v32, v32, v74, v75
    v_max3_f32 v34, v34, v76, v77
    v_max3_f32 v32, v32, v78, v79
    v_max_f32 v32, v32, v34
    s_nop 1
    v_max_f32_dpp v32, v32, v32 row_ror:8 row_mask:0xf bank_mask:0xf
    s_nop 1
    v_max_f32_dpp v32, v32, v32 row_ror:4 row_mask:0xf bank_mask:0xf
    s_nop 1
    v_max_f32_dpp v32, v32, v32 row_ror:2 row_mask:0xf bank_mask:0xf
    s_nop 1
    v_max_f32_dpp v32, v32, v32 row_ror:1 row_mask:0xf bank_mask:0xf
    v_mov_b32 v34, v32
    s_nop 1
    v_permlane16_swap_b32 v32, v34
    v_max_f32 v32, v32, v34
    v_mov_b32 v34, v32
    s_nop 1
    v_permlane32_swap_b32 v32, v34
    v_max_f32 v32, v32, v34
    v_sub_f32 v80, v64, v32
    v_sub_f32 v81, v65, v32
    v_sub_f32 v82, v66, v32
    v_sub_f32 v83, v67, v32
    v_sub_f32 v84, v68, v32
    v_sub_f32 v85, v69, v32
    v_sub_f32 v86, v70, v32
    v_sub_f32 v87, v71, v32
    v_sub_f32 v88, v72, v32
    v_sub_f32 v89, v73, v32
    v_sub_f32 v90, v74, v32
    v_sub_f32 v91, v75, v32
    v_sub_f32 v92, v76, v32
    v_sub_f32 v93, v77, v32
    v_sub_f32 v94, v78, v32
    v_sub_f32 v95, v79, v32
    v_mul_f32 v80, 0x3db8aa3b, v80
    v_mul_f32 v81, 0x3db8aa3b, v81
    v_mul_f32 v82, 0x3db8aa3b, v82
    v_mul_f32 v83, 0x3db8aa3b, v83
    v_mul_f32 v84, 0x3db8aa3b, v84
    v_mul_f32 v85, 0x3db8aa3b, v85
    v_mul_f32 v86, 0x3db8aa3b, v86
    v_mul_f32 v87, 0x3db8aa3b, v87
    v_mul_f32 v88, 0x3db8aa3b, v88
    v_mul_f32 v89, 0x3db8aa3b, v89
    v_mul_f32 v90, 0x3db8aa3b, v90
    v_mul_f32 v91, 0x3db8aa3b, v91
    v_mul_f32 v92, 0x3db8aa3b, v92
    v_mul_f32 v93, 0x3db8aa3b, v93
    v_mul_f32 v94, 0x3db8aa3b, v94
    v_mul_f32 v95, 0x3db8aa3b, v95
    v_exp_f32 v80, v80
    v_exp_f32 v81, v81
    v_exp_f32 v82, v82
    v_exp_f32 v83, v83
    v_exp_f32 v84, v84
    v_exp_f32 v85, v85
    v_exp_f32 v86, v86
    v_exp_f32 v87, v87
    v_exp_f32 v88, v88
    v_exp_f32 v89, v89
    v_exp_f32 v90, v90
    v_exp_f32 v91, v91
    v_exp_f32 v92, v92
    v_exp_f32 v93, v93
    v_exp_f32 v94, v94
    v_exp_f32 v95, v95
    v_add_f32 v33, v80, v81
    v_add_f32 v34, v82, v83
    v_add_f32 v33, v33, v84
    v_add_f32 v34, v34, v85
    v_add_f32 v33, v33, v86
    v_add_f32 v34, v34, v87
    v_add_f32 v33, v33, v88
    v_add_f32 v34, v34, v89
    v_add_f32 v33, v33, v90
    v_add_f32 v34, v34, v91
    v_add_f32 v33, v33, v92
    v_add_f32 v34, v34, v93
    v_add_f32 v33, v33, v94
    v_add_f32 v34, v34, v95
    v_add_f32 v33, v33, v34
    s_nop 1
    v_add_f32_dpp v33, v33, v33 row_ror:8 row_mask:0xf bank_mask:0xf
    s_nop 1
    v_add_f32_dpp v33, v33, v33 row_ror:4 row_mask:0xf bank_mask:0xf
    s_nop 1
    v_add_f32_dpp v33, v33, v33 row_ror:2 row_mask:0xf bank_mask:0xf
    s_nop 1
    v_add_f32_dpp v33, v33, v33 row_ror:1 row_mask:0xf bank_mask:0xf
    v_mov_b32 v34, v33
    s_nop 1
    v_permlane16_swap_b32 v33, v34
    v_add_f32 v33, v33, v34
    v_mov_b32 v34, v33
    s_nop 1
    v_permlane32_swap_b32 v33, v34
    v_add_f32 v33, v33, v34
    s_waitcnt vmcnt(0)
    s_mov_b64 exec, 1
    ds_write_b64 v10, v[32:33] offset:30208
    ds_add_u32 v46, v47 offset:4
    s_mov_b64 exec, -1
    s_cmp_lg_u32 s34, 0
    s_cbranch_scc1 L_mlwait
L_sy_548:
    ds_read_b32 v34, v46 offset:4
    s_waitcnt lgkmcnt(0)
    v_readfirstlane_b32 s56, v34
    s_cmp_ge_u32 s56, 4
    s_cbranch_scc1 L_syd_549
    s_sub_u32 s74, s74, 1
    s_cmp_gt_i32 s74, 0
    s_cbranch_scc1 L_sy_548
L_syd_549:
    ds_read_b64 v[36:37], v11 offset:30208
    s_waitcnt lgkmcnt(0)
    v_mov_b32 v40, v36
    v_mov_b32 v34, v40
    s_nop 1
    v_permlane16_swap_b32 v40, v34
    v_max_f32 v40, v40, v34
    v_mov_b32 v34, v40
    s_nop 1
    v_permlane32_swap_b32 v40, v34
    v_max_f32 v40, v40, v34
    v_sub_f32 v36, v36, v40
    v_mul_f32 v36, 0x3db8aa3b, v36
    v_exp_f32 v36, v36
    v_mov_b32 v41, s101
    v_mul_f32 v42, v36, v37
    v_mov_b32 v43, s101
    v_mov_b32 v34, v42
    s_nop 1
    v_permlane16_swap_b32 v42, v34
    v_add_f32 v42, v42, v34
    v_mov_b32 v34, v42
    s_nop 1
    v_permlane32_swap_b32 v42, v34
    v_add_f32 v42, v42, v34
    s_mov_b64 exec, 1
    buffer_store_dwordx4 v[40:43], off, s[44:47], s59 sc1
    s_mov_b64 exec, -1
    s_waitcnt vmcnt(0)
    buffer_load_dwordx4 v[36:39], v9, s[44:47], s75 offen sc1
L_tp_550:
    s_waitcnt vmcnt(0)
    v_cmp_ne_u32 s[4:5], s101, v37
    v_cmp_ne_u32 s[6:7], s101, v39
    s_or_b64 vcc, s[4:5], s[6:7]
    s_cbranch_scc0 L_tpd_551
    s_sleep 8
    buffer_load_dwordx4 v[36:39], v9, s[44:47], s75 offen sc1
    s_sub_u32 s74, s74, 1
    s_cmp_gt_i32 s74, 0
    s_cbranch_scc1 L_tp_550
    s_waitcnt vmcnt(0)
L_tpd_551:
    v_mov_b32 v32, v36
    s_nop 1
    v_max_f32_dpp v32, v32, v32 row_ror:4 row_mask:0xf bank_mask:0xf
    s_nop 1
    v_max_f32_dpp v32, v32, v32 row_ror:2 row_mask:0xf bank_mask:0xf
    s_nop 1
    v_max_f32_dpp v32, v32, v32 row_ror:1 row_mask:0xf bank_mask:0xf
    v_sub_f32 v36, v36, v32
    v_mul_f32 v36, 0x3db8aa3b, v36
    v_exp_f32 v36, v36
    s_nop 0
    v_mul_f32 v33, v36, v38
    s_nop 1
    v_add_f32_dpp v33, v33, v33 row_ror:4 row_mask:0xf bank_mask:0xf
    s_nop 1
    v_add_f32_dpp v33, v33, v33 row_ror:2 row_mask:0xf bank_mask:0xf
    s_nop 1
    v_add_f32_dpp v33, v33, v33 row_ror:1 row_mask:0xf bank_mask:0xf
    v_rcp_f32 v33, v33
    s_mov_b64 exec, 1
    ds_write_b64 v10, v[32:33] offset:30240
    ds_add_u32 v46, v47 offset:8
    s_mov_b64 exec, -1
    s_branch L_mlgot
.p2align 12
L_brk2_552:
    s_setpc_b64 s[4:5]
L_brk2_552s:
L_mlwait:
L_sy_553:
    ds_read_b32 v34, v46 offset:8
    s_waitcnt lgkmcnt(0)
    v_readfirstlane_b32 s56, v34
    s_cmp_ge_u32 s56, 1
    s_cbranch_scc1 L_syd_554
    s_sleep 1
    s_sub_u32 s74, s74, 1
    s_cmp_gt_i32 s74, 0
    s_cbranch_scc1 L_sy_553
L_syd_554:
    ds_read_b64 v[32:33], v46 offset:13344
    s_waitcnt lgkmcnt(0)
L_mlgot:
    v_sub_f32 v80, v64, v32
    v_sub_f32 v81, v65, v32
    v_sub_f32 v82, v66, v32
    v_sub_f32 v83, v67, v32
    v_sub_f32 v84, v68, v32
    v_sub_f32 v85, v69, v32
    v_sub_f32 v86, v70, v32
    v_sub_f32 v87, v71, v32
    v_sub_f32 v88, v72, v32
    v_sub_f32 v89, v73, v32
    v_sub_f32 v90, v74, v32
    v_sub_f32 v91, v75, v32
    v_sub_f32 v92, v76, v32
    v_sub_f32 v93, v77, v32
    v_sub_f32 v94, v78, v32
    v_sub_f32 v95, v79, v32
    v_mul_f32 v80, 0x3db8aa3b, v80
    v_mul_f32 v81, 0x3db8aa3b, v81
    v_mul_f32 v82, 0x3db8aa3b, v82
    v_mul_f32 v83, 0x3db8aa3b, v83
    v_mul_f32 v84, 0x3db8aa3b, v84
    v_mul_f32 v85, 0x3db8aa3b, v85
    v_mul_f32 v86, 0x3db8aa3b, v86
    v_mul_f32 v87, 0x3db8aa3b, v87
    v_mul_f32 v88, 0x3db8aa3b, v88
    v_mul_f32 v89, 0x3db8aa3b, v89
    v_mul_f32 v90, 0x3db8aa3b, v90
    v_mul_f32 v91, 0x3db8aa3b, v91
    v_mul_f32 v92, 0x3db8aa3b, v92
    v_mul_f32 v93, 0x3db8aa3b, v93
    v_mul_f32 v94, 0x3db8aa3b, v94
    v_mul_f32 v95, 0x3db8aa3b, v95
    v_exp_f32 v80, v80
    v_exp_f32 v81, v81
    v_exp_f32 v82, v82
    v_exp_f32 v83, v83
    v_exp_f32 v84, v84
    v_exp_f32 v85, v85
    v_exp_f32 v86, v86
    v_exp_f32 v87, v87
    v_exp_f32 v88, v88
    v_exp_f32 v89, v89
    v_exp_f32 v90, v90
    v_exp_f32 v91, v91
    v_exp_f32 v92, v92
    v_exp_f32 v93, v93
    v_exp_f32 v94, v94
    v_exp_f32 v95, v95
    v_mul_f32 v80, v80, v33
    v_mul_f32 v81, v81, v33
    v_mul_f32 v82, v82, v33
    v_mul_f32 v83, v83, v33
    v_mul_f32 v84, v84, v33
    v_mul_f32 v85, v85, v33
    v_mul_f32 v86, v86, v33
    v_mul_f32 v87, v87, v33
    v_mul_f32 v88, v88, v33
    v_mul_f32 v89, v89, v33
    v_mul_f32 v90, v90, v33
    v_mul_f32 v91, v91, v33
    v_mul_f32 v92, v92, v33
    v_mul_f32 v93, v93, v33
    v_mul_f32 v94, v94, v33
    v_mul_f32 v95, v95, v33
    v_cvt_pk_bf16_f32 v80, v80, v80
    v_cvt_pk_bf16_f32 v81, v81, v81
    v_cvt_pk_bf16_f32 v82, v82, v82
    v_cvt_pk_bf16_f32 v83, v83, v83
    v_cvt_pk_bf16_f32 v84, v84, v84
    v_cvt_pk_bf16_f32 v85, v85, v85
    v_cvt_pk_bf16_f32 v86, v86, v86
    v_cvt_pk_bf16_f32 v87, v87, v87
    v_cvt_pk_bf16_f32 v88, v88, v88
    v_cvt_pk_bf16_f32 v89, v89, v89
    v_cvt_pk_bf16_f32 v90, v90, v90
    v_cvt_pk_bf16_f32 v91, v91, v91
    v_cvt_pk_bf16_f32 v92, v92, v92
    v_cvt_pk_bf16_f32 v93, v93, v93
    v_cvt_pk_bf16_f32 v94, v94, v94
    v_cvt_pk_bf16_f32 v95, v95, v95
    ds_write_b128 v8, v[80:83] offset:0
    ds_write_b128 v8, v[84:87] offset:1024
    ds_write_b128 v8, v[88:91] offset:2048
    ds_write_b128 v8, v[92:95] offset:3072
    s_waitcnt lgkmcnt(0)
    s_barrier
    s_cmp_eq_u32 s97, 0
    s_cbranch_scc1 L_service_done
    v_lshrrev_b32 v11, 3, v0
    v_mul_u32_u24 v11, 4352, v11
    v_add_u32 v11, v11, v9
    s_mul_i32 s58, s34, 34816
    s_add_u32 s58, s58, 0x90000
    buffer_load_dword v32, v11, s[44:47], s58 offen offset:4
L_tp_555:
    s_waitcnt vmcnt(0)
    v_cmp_ne_u32 s[4:5], s101, v32
    s_or_b64 vcc, s[4:5], s[4:5]
    s_cbranch_scc0 L_tpd_556
    s_sleep 64
    buffer_load_dword v32, v11, s[44:47], s58 offen offset:4 sc1
    s_sub_u32 s74, s74, 1
    s_cmp_gt_i32 s74, 0
    s_cbranch_scc1 L_tp_555
    s_waitcnt vmcnt(0)
L_tpd_556:
    v_and_b32 v5, 1, v1
    s_cmp_eq_u32 s97, 2
    s_cbranch_scc1 L_stage2
    s_branch L_brk2_557s
L_brk2_557:
    s_setpc_b64 s[4:5]
L_brk2_557s:
    v_lshrrev_b32 v6, 3, v0
    v_and_b32 v7, 7, v0
    v_mul_u32_u24 v14, 7168, v6
    v_lshl_add_u32 v14, v7, 4, v14
    v_mul_u32_u24 v8, 1024, v3
    v_lshl_add_u32 v8, v4, 4, v8
    s_lshr_b32 s56, s34, 1
    s_add_u32 s56, s56, s33
    s_lshl_b32 s57, s32, 4
    s_add_u32 s56, s56, s57
    s_mul_i32 s56, s56, 8192
    s_and_b32 s57, s34, 1
    s_lshl_b32 s57, s57, 9
    s_add_u32 s56, s56, s57
    s_add_u32 s20, s56, 0x280000
    s_add_u32 s21, s20, 2048
    s_add_u32 s22, s21, 2048
    s_add_u32 s23, s22, 2048
    s_lshl_b32 s56, s34, 9
    v_lshlrev_b32 v11, 3, v4
    v_lshl_add_u32 v11, v3, 2, v11
    v_add_u32 v9, s56, v11
    v_lshl_add_u32 v10, v6, 4, s56
    s_add_u32 s56, s56, 21504
    v_lshlrev_b32 v11, 5, v7
    v_lshl_add_u32 v11, v3, 8, v11
    v_add_u32 v12, s56, v11
    v_lshlrev_b32 v15, 4, v2
    v_lshl_add_u32 v13, v1, 9, v15
    s_lshl_b32 s58, s33, 1
    s_add_u32 s58, s58, s34
    s_mul_i32 s58, s58, 114688
    s_lshl_b32 s56, s98, 7
    s_add_u32 s58, s58, s56
    s_movk_i32 s59, 896
    s_mul_i32 s24, s33, 1024
    s_lshl_b32 s57, s32, 17
    s_add_u32 s24, s24, s57
    s_lshl_b32 s57, s98, 8
    s_add_u32 s24, s24, s57
    s_add_u32 s24, s24, 0x100000
    v_mov_b32 v31, 16896
    v_mov_b32 v3, 1
    s_barrier
    buffer_load_dwordx4 v[128:131], v14, s[60:63], s58 offen
    s_add_u32 s58, s58, s59
    buffer_load_dwordx4 v[132:135], v14, s[60:63], s58 offen
    s_add_u32 s58, s58, s59
    buffer_load_dwordx4 v[136:139], v14, s[60:63], s58 offen
    s_add_u32 s58, s58, s59
    buffer_load_dwordx4 v[140:143], v14, s[60:63], s58 offen
    s_add_u32 s58, s58, s59
    buffer_load_dwordx4 v[144:147], v14, s[60:63], s58 offen
    s_add_u32 s58, s58, s59
    buffer_load_dwordx4 v[148:151], v14, s[60:63], s58 offen
    s_add_u32 s58, s58, s59
    buffer_load_dwordx4 v[152:155], v14, s[60:63], s58 offen
    s_add_u32 s58, s58, s59
    buffer_load_dwordx4 v[156:159], v14, s[60:63], s58 offen
    s_add_u32 s58, s58, s59
    s_add_u32 s58, s58, 50176
    buffer_load_dwordx4 v[160:163], v14, s[60:63], s58 offen
    s_add_u32 s58, s58, s59
    buffer_load_dwordx4 v[164:167], v14, s[60:63], s58 offen
    s_add_u32 s58, s58, s59
    buffer_load_dwordx4 v[168:171], v14, s[60:63], s58 offen
    s_add_u32 s58, s58, s59
    buffer_load_dwordx4 v[172:175], v14, s[60:63], s58 offen
    s_add_u32 s58, s58, s59
    buffer_load_dwordx4 v[176:179], v14, s[60:63], s58 offen
    s_add_u32 s58, s58, s59
    buffer_load_dwordx4 v[180:183], v14, s[60:63], s58 offen
    s_add_u32 s58, s58, s59
    buffer_load_dwordx4 v[184:187], v14, s[60:63], s58 offen
    s_add_u32 s58, s58, s59
    buffer_load_dwordx4 v[188:191], v14, s[60:63], s58 offen
    s_add_u32 s58, s58, s59
    s_waitcnt vmcnt(14)
    v_perm_b32 v192, v132, v128, s72
    v_perm_b32 v196, v132, v128, s73
    v_perm_b32 v200, v133, v129, s72
    v_perm_b32 v204, v133, v129, s73
    v_perm_b32 v208, v134, v130, s72
    v_perm_b32 v212, v134, v130, s73
    v_perm_b32 v216, v135, v131, s72
    v_perm_b32 v220, v135, v131, s73
    s_waitcnt vmcnt(12)
    v_perm_b32 v193, v140, v136, s72
    v_perm_b32 v197, v140, v136, s73
    v_perm_b32 v201, v141, v137, s72
    v_perm_b32 v205, v141, v137, s73
    v_perm_b32 v209, v142, v138, s72
    v_perm_b32 v213, v142, v138, s73
    v_perm_b32 v217, v143, v139, s72
    v_perm_b32 v221, v143, v139, s73
    s_waitcnt vmcnt(10)
    v_perm_b32 v194, v148, v144, s72
    v_perm_b32 v198, v148, v144, s73
    v_perm_b32 v202, v149, v145, s72
    v_perm_b32 v206, v149, v145, s73
    v_perm_b32 v210, v150, v146, s72
    v_perm_b32 v214, v150, v146, s73
    v_perm_b32 v218, v151, v147, s72
    v_perm_b32 v222, v151, v147, s73
    s_waitcnt vmcnt(8)
    v_perm_b32 v195, v156, v152, s72
    v_perm_b32 v199, v156, v152, s73
    v_perm_b32 v203, v157, v153, s72
    v_perm_b32 v207, v157, v153, s73
    v_perm_b32 v211, v158, v154, s72
    v_perm_b32 v215, v158, v154, s73
    v_perm_b32 v219, v159, v155, s72
    v_perm_b32 v223, v159, v155, s73
    s_waitcnt vmcnt(6)
    v_perm_b32 v224, v164, v160, s72
    v_perm_b32 v228, v164, v160, s73
    v_perm_b32 v232, v165, v161, s72
    v_perm_b32 v236, v165, v161, s73
    v_perm_b32 v240, v166, v162, s72
    v_perm_b32 v244, v166, v162, s73
    v_perm_b32 v248, v167, v163, s72
    v_perm_b32 v252, v167, v163, s73
    s_waitcnt vmcnt(4)
    v_perm_b32 v225, v172, v168, s72
    v_perm_b32 v229, v172, v168, s73
    v_perm_b32 v233, v173, v169, s72
    v_perm_b32 v237, v173, v169, s73
    v_perm_b32 v241, v174, v170, s72
    v_perm_b32 v245, v174, v170, s73
    v_perm_b32 v249, v175, v171, s72
    v_perm_b32 v253, v175, v171, s73
    s_waitcnt vmcnt(2)
    v_perm_b32 v226, v180, v176, s72
    v_perm_b32 v230, v180, v176, s73
    v_perm_b32 v234, v181, v177, s72
    v_perm_b32 v238, v181, v177, s73
    v_perm_b32 v242, v182, v178, s72
    v_perm_b32 v246, v182, v178, s73
    v_perm_b32 v250, v183, v179, s72
    v_perm_b32 v254, v183, v179, s73
    s_waitcnt vmcnt(0)
    v_perm_b32 v227, v188, v184, s72
    v_perm_b32 v231, v188, v184, s73
    v_perm_b32 v235, v189, v185, s72
    v_perm_b32 v239, v189, v185, s73
    v_perm_b32 v243, v190, v186, s72
    v_perm_b32 v247, v190, v186, s73
    v_perm_b32 v251, v191, v187, s72
    v_perm_b32 v255, v191, v187, s73
    buffer_load_dwordx4 v[96:99], v8, s[44:47], s20 offen sc1
    buffer_load_dwordx4 v[100:103], v8, s[44:47], s21 offen sc1
    buffer_load_dwordx4 v[104:107], v8, s[44:47], s22 offen sc1
    buffer_load_dwordx4 v[108:111], v8, s[44:47], s23 offen sc1
    s_branch L_pc_559
L_brk2_562:
    s_setpc_b64 s[4:5]
L_brk2_562s:
L_pf_561:
    s_mov_b64 s[4:5], 0
    v_max3_u32 v30, v96, v97, v98
    v_max_u32 v30, v30, v99
    v_cmp_eq_u32 vcc, -1, v30
    s_or_b64 s[4:5], s[4:5], vcc
    s_mov_b64 exec, vcc
    s_cbranch_execz L_sk_563
    buffer_load_dwordx4 v[96:99], v8, s[44:47], s20 offen sc1
L_sk_563:
    s_mov_b64 exec, -1
    v_max3_u32 v30, v100, v101, v102
    v_max_u32 v30, v30, v103
    v_cmp_eq_u32 vcc, -1, v30
    s_or_b64 s[4:5], s[4:5], vcc
    s_mov_b64 exec, vcc
    s_cbranch_execz L_sk_564
    buffer_load_dwordx4 v[100:103], v8, s[44:47], s21 offen sc1
L_sk_564:
    s_mov_b64 exec, -1
    v_max3_u32 v30, v104, v105, v106
    v_max_u32 v30, v30, v107
    v_cmp_eq_u32 vcc, -1, v30
    s_or_b64 s[4:5], s[4:5], vcc
    s_mov_b64 exec, vcc
    s_cbranch_execz L_sk_565
    buffer_load_dwordx4 v[104:107], v8, s[44:47], s22 offen sc1
L_sk_565:
    s_mov_b64 exec, -1
    v_max3_u32 v30, v108, v109, v110
    v_max_u32 v30, v30, v111
    v_cmp_eq_u32 vcc, -1, v30
    s_or_b64 s[4:5], s[4:5], vcc
    s_mov_b64 exec, vcc
    s_cbranch_execz L_sk_566
    buffer_load_dwordx4 v[108:111], v8, s[44:47], s23 offen sc1
L_sk_566:
    s_mov_b64 exec, -1
    s_cmp_eq_u64 s[4:5], 0
    s_cbranch_scc1 L_pd_560
    s_cmp_gt_i32 s74, 0
    s_cbranch_scc1 L_pc_559
    s_waitcnt vmcnt(0)
    s_branch L_pd_560
L_pr_558:
    s_sub_u32 s74, s74, 1
    s_and_b32 s56, s74, 63
    s_cbranch_scc0 L_pf_561
    v_cmp_eq_u32 s[4:5], -1, v99
    v_cmp_eq_u32 s[6:7], -1, v103
    v_cmp_eq_u32 s[8:9], -1, v107
    v_cmp_eq_u32 s[10:11], -1, v111
    s_mov_b64 exec, s[4:5]
    s_cbranch_execz L_sk_567
    buffer_load_dwordx4 v[96:99], v8, s[44:47], s20 offen sc1
L_sk_567:
    s_mov_b64 exec, s[6:7]
    s_cbranch_execz L_sk_568
    buffer_load_dwordx4 v[100:103], v8, s[44:47], s21 offen sc1
L_sk_568:
    s_mov_b64 exec, s[8:9]
    s_cbranch_execz L_sk_569
    buffer_load_dwordx4 v[104:107], v8, s[44:47], s22 offen sc1
L_sk_569:
    s_mov_b64 exec, s[10:11]
    s_cbranch_execz L_sk_570
    buffer_load_dwordx4 v[108:111], v8, s[44:47], s23 offen sc1
L_sk_570:
L_pc_559:
    s_mov_b64 exec, -1
    s_waitcnt vmcnt(0)
    v_pk_add_f32 v[32:33], v[96:97], v[100:101]
    v_pk_add_f32 v[34:35], v[98:99], v[102:103]
    v_pk_add_f32 v[36:37], v[104:105], v[108:109]
    v_pk_add_f32 v[38:39], v[106:107], v[110:111]
    v_pk_add_f32 v[32:33], v[32:33], v[36:37]
    v_pk_add_f32 v[34:35], v[34:35], v[38:39]
    s_nop 1
    v_permlane32_swap_b32 v32, v34
    v_permlane32_swap_b32 v33, v35
    v_pk_add_f32 v[32:33], v[32:33], v[34:35]
    v_cmp_u_f32 vcc, v32, v33
    s_cbranch_vccnz L_pr_558
L_pd_560:
    v_cvt_pk_bf16_f32 v32, v32, v33
    ds_write_b32 v9, v32 offset:25600
    ds_read_b128 v[48:51], v10 offset:25600
    ds_read_b128 v[52:55], v10 offset:25728
    s_waitcnt lgkmcnt(0)
    v_mfma_f32_16x16x32_bf16 v[56:59], v[48:51], v[192:195], 0
    v_mfma_f32_16x16x32_bf16 v[60:63], v[48:51], v[196:199], 0
    v_mfma_f32_16x16x32_bf16 v[64:67], v[48:51], v[200:203], 0
    v_mfma_f32_16x16x32_bf16 v[68:71], v[48:51], v[204:207], 0
    v_mfma_f32_16x16x32_bf16 v[72:75], v[48:51], v[208:211], 0
    v_mfma_f32_16x16x32_bf16 v[76:79], v[48:51], v[212:215], 0
    v_mfma_f32_16x16x32_bf16 v[80:83], v[48:51], v[216:219], 0
    v_mfma_f32_16x16x32_bf16 v[84:87], v[48:51], v[220:223], 0
    v_mfma_f32_16x16x32_bf16 v[56:59], v[52:55], v[224:227], v[56:59]
    v_mfma_f32_16x16x32_bf16 v[60:63], v[52:55], v[228:231], v[60:63]
    v_mfma_f32_16x16x32_bf16 v[64:67], v[52:55], v[232:235], v[64:67]
    v_mfma_f32_16x16x32_bf16 v[68:71], v[52:55], v[236:239], v[68:71]
    v_mfma_f32_16x16x32_bf16 v[72:75], v[52:55], v[240:243], v[72:75]
    v_mfma_f32_16x16x32_bf16 v[76:79], v[52:55], v[244:247], v[76:79]
    v_mfma_f32_16x16x32_bf16 v[80:83], v[52:55], v[248:251], v[80:83]
    v_mfma_f32_16x16x32_bf16 v[84:87], v[52:55], v[252:255], v[84:87]
    s_mov_b32 exec_lo, 0xff
    s_mov_b32 exec_hi, 0xff00
    ds_write2_b32 v12, v56, v60 offset0:0 offset1:1
    s_nop 0
    ds_write2_b32 v12, v64, v68 offset0:2 offset1:3
    s_nop 0
    ds_write2_b32 v12, v72, v76 offset0:4 offset1:5
    s_nop 0
    ds_write2_b32 v12, v80, v84 offset0:6 offset1:7
    s_mov_b64 exec, -1
    s_waitcnt lgkmcnt(0)
    s_barrier
    s_cmp_lg_u32 s34, 0
    s_cbranch_scc1 L_end1
    s_mov_b64 exec, 0xffff
    ds_read_b128 v[128:131], v15 offset:21504
    ds_read_b128 v[132:135], v15 offset:21760
    ds_read_b128 v[136:139], v15 offset:22016
    ds_read_b128 v[140:143], v15 offset:22272
    ds_read_b128 v[144:147], v15 offset:22528
    ds_read_b128 v[148:151], v15 offset:22784
    ds_read_b128 v[152:155], v15 offset:23040
    ds_read_b128 v[156:159], v15 offset:23296
    s_waitcnt lgkmcnt(0)
    v_pk_add_f32 v[32:33], v[128:129], v[132:133]
    v_pk_add_f32 v[34:35], v[130:131], v[134:135]
    v_pk_add_f32 v[36:37], v[136:137], v[140:141]
    v_pk_add_f32 v[38:39], v[138:139], v[142:143]
    v_pk_add_f32 v[40:41], v[144:145], v[148:149]
    v_pk_add_f32 v[42:43], v[146:147], v[150:151]
    v_pk_add_f32 v[44:45], v[152:153], v[156:157]
    v_pk_add_f32 v[46:47], v[154:155], v[158:159]
    v_pk_add_f32 v[32:33], v[32:33], v[40:41]
    v_pk_add_f32 v[34:35], v[34:35], v[42:43]
    v_pk_add_f32 v[36:37], v[36:37], v[44:45]
    v_pk_add_f32 v[38:39], v[38:39], v[46:47]
    v_pk_add_f32 v[32:33], v[32:33], v[36:37]
    v_pk_add_f32 v[34:35], v[34:35], v[38:39]
    v_min_u32 v32, -2, v32
    v_min_u32 v33, -2, v33
    v_min_u32 v34, -2, v34
    v_min_u32 v35, -2, v35
    buffer_store_dwordx4 v[32:35], v15, s[44:47], s24 offen sc1
L_end1:
    s_branch L_service_done
L_brk2_571:
    s_setpc_b64 s[4:5]
L_brk2_571s:
L_stage2:
    s_mov_b32 s48, s99
    s_mov_b32 s49, s99
    s_mov_b32 s50, 0xffff0000
    s_mov_b32 s51, 0xffff0000
    s_lshl_b32 s56, s34, 9
    v_lshlrev_b32 v11, 3, v4
    v_lshl_add_u32 v11, v3, 2, v11
    v_add_u32 v9, s56, v11
    v_lshlrev_b32 v27, 1, v11
    v_add_u32 v27, s56, v27
    v_cndmask_b32 v33, 0, v27, s[48:49]
    v_mul_u32_u24 v8, 2048, v3
    v_lshl_add_u32 v8, v4, 4, v8
    v_add_u32 v8, s56, v8
    v_lshrrev_b32 v6, 2, v0
    v_and_b32 v7, 3, v0
    v_lshl_add_u32 v10, v6, 4, s56
    v_lshlrev_b32 v11, 5, v7
    v_lshl_add_u32 v11, v1, 7, v11
    v_lshlrev_b32 v13, 2, v4
    v_lshl_add_u32 v13, v3, 10, v13
    v_add_u32 v11, s56, v11
    v_add_u32 v12, 21504, v11
    v_add_u32 v13, 21504, v13
    v_lshlrev_b32 v15, 5, v2
    v_lshl_add_u32 v15, v5, 4, v15
    v_add_u32 v15, s56, v15
    v_and_b32 v34, 1, v0
    v_lshlrev_b32 v35, 2, v34
    v_lshl_add_u32 v35, v3, 1, v35
    v_add_u32 v35, v35, v5
    s_lshl_b32 s57, s98, 5
    v_lshl_add_u32 v28, v35, 2, s57
    v_and_b32 v36, -8, v28
    v_lshrrev_b32 v35, 1, v0
    v_mul_u32_u24 v35, 2048, v35
    v_lshl_add_u32 v35, v34, 4, v35
    v_add_u32 v88, s57, v35
    s_lshl_b32 s58, s32, 14
    s_add_u32 s58, s58, 3584
    s_add_u32 s59, s58, 5376
    buffer_load_dwordx2 v[16:17], v33, s[44:47], s58 offen sc1
    buffer_load_dwordx2 v[18:19], v33, s[44:47], s58 offen offset:1792 sc1
    buffer_load_dwordx2 v[20:21], v33, s[44:47], s58 offen offset:3584 sc1
    buffer_load_dwordx2 v[34:35], v36, s[44:47], s59 offen sc1
L_tp_572:
    s_waitcnt vmcnt(0)
    v_cmp_ne_u32 s[4:5], s101, v17
    v_cmp_ne_u32 s[6:7], s101, v19
    v_cmp_ne_u32 s[8:9], s101, v21
    v_cmp_ne_u32 s[10:11], s101, v35
    s_or_b64 vcc, s[4:5], s[10:11]
    s_or_b64 vcc, vcc, s[6:7]
    s_or_b64 vcc, vcc, s[8:9]
    s_cbranch_scc0 L_tpd_573
    s_sleep 8
    buffer_load_dwordx2 v[16:17], v33, s[44:47], s58 offen sc1
    buffer_load_dwordx2 v[18:19], v33, s[44:47], s58 offen offset:1792 sc1
    buffer_load_dwordx2 v[20:21], v33, s[44:47], s58 offen offset:3584 sc1
    buffer_load_dwordx2 v[34:35], v36, s[44:47], s59 offen sc1
    s_sub_u32 s74, s74, 1
    s_cmp_gt_i32 s74, 0
    s_cbranch_scc1 L_tp_572
    s_waitcnt vmcnt(0)
L_tpd_573:
    v_lshrrev_b32 v33, 1, v33
    s_mul_i32 s56, s32, 896
    buffer_load_dword v22, v33, s[52:55], s56 offen
    v_and_b32 v17, 0xffff0000, v16
    v_lshlrev_b32 v16, 16, v16
    v_and_b32 v19, 0xffff0000, v18
    v_lshlrev_b32 v18, 16, v18
    v_and_b32 v21, 0xffff0000, v20
    v_lshlrev_b32 v20, 16, v20
    v_lshlrev_b32 v35, 4, v5
    v_lshrrev_b32 v34, v35, v34
    v_lshlrev_b32 v24, 16, v34
    v_lshrrev_b32 v89, 1, v28
    v_add_u32 v89, s56, v89
    v_add_f32 v20, 1.0, v20
    v_add_f32 v21, 1.0, v21
    v_cvt_pk_bf16_f32 v32, v20, v21
    v_lshlrev_b32 v20, 16, v32
    v_and_b32 v21, 0xffff0000, v32
    v_cndmask_b32 v18, 0, v18, s[48:49]
    v_cndmask_b32 v19, 0, v19, s[48:49]
    v_cndmask_b32 v20, 0, v20, s[48:49]
    v_cndmask_b32 v21, 0, v21, s[48:49]
    s_lshl_b32 s56, s34, 7
    v_lshl_add_u32 v25, v4, 1, s56
    v_lshl_add_u32 v26, v1, 4, s56
    s_lshl_b32 s56, s34, 2
    s_add_u32 s56, s56, 30208
    v_lshl_add_u32 v29, v3, 4, s56
    v_mov_b32 v91, 30208
    v_mov_b32 v92, 0x43000000
    v_mov_b32 v93, 0x43000000
    v_mov_b32 v94, 0x43000000
    v_mov_b32 v95, 0x42800000
    s_lshl_b32 s56, s34, 4
    v_add_u32 v32, s56, v6
    v_mul_u32_u24 v32, 28672, v32
    v_lshl_add_u32 v32, v7, 4, v32
    s_lshl_b32 s56, s98, 6
    v_add_u32 v14, s56, v32
    v_add_u32 v11, 229376, v14
    v_mul_u32_u24 v90, 7168, v1
    v_lshl_add_u32 v90, v2, 4, v90
    s_mul_i32 s39, s98, 28672
    s_lshl_b32 s56, s34, 8
    s_add_u32 s39, s39, s56
    s_movk_i32 s38, 896
    s_lshl_b32 s56, s32, 17
    s_add_u32 s20, s56, 0x100000
    s_add_u32 s21, s20, 4096
    s_add_u32 s22, s21, 4096
    s_add_u32 s23, s22, 4096
    s_mul_i32 s56, s32, 131072
    s_add_u32 s28, s56, 0x140000
    s_mul_i32 s57, s98, 2048
    s_add_u32 s36, s28, s57
    s_add_u32 s37, s28, 65536
    s_cmp_eq_u32 s34, 3
    s_cselect_b32 s29, 0x00ff00ff, -1
    s_movk_i32 s59, 3584
    s_mov_b32 s58, 0
    s_waitcnt vmcnt(0)
    v_and_b32 v23, 0xffff0000, v22
    v_lshlrev_b32 v22, 16, v22
    s_branch L_brk2_574s
.p2align 12
L_brk2_574:
    s_setpc_b64 s[4:5]
L_brk2_574s:
    s_barrier
    s_lshl_b32 s56, s34, 8
    s_or_b32 s56, s56, s2
    s_cmp_lg_u32 s56, 8
    s_cbranch_scc1 L_nobump
    s_add_u32 s57, s100, 1
    v_mov_b32 v30, 0x88000
    v_mov_b32 v31, s57
    s_mov_b64 exec, 1
    buffer_store_dword v31, v30, s[44:47], 0 offen sc1
    s_mov_b64 exec, -1
L_nobump:
    v_mov_b32 v31, 16896
    v_mov_b32 v3, 1
    v_mov_b32 v31, 16896
L_sy_575:
    ds_read_b32 v30, v31 offset:12
    s_waitcnt lgkmcnt(0)
    v_readfirstlane_b32 s56, v30
    s_cmp_ge_u32 s56, 4
    s_cbranch_scc1 L_syd_576
    s_sub_u32 s74, s74, 1
    s_cmp_gt_i32 s74, 0
    s_cbranch_scc1 L_sy_575
L_syd_576:
    buffer_load_dwordx4 v[128:131], v14, s[60:63], s58 offen
    s_add_u32 s58, s58, s59
    buffer_load_dwordx4 v[132:135], v14, s[60:63], s58 offen
    s_add_u32 s58, s58, s59
    buffer_load_dwordx4 v[136:139], v14, s[60:63], s58 offen
    s_add_u32 s58, s58, s59
    buffer_load_dwordx4 v[140:143], v14, s[60:63], s58 offen
    s_add_u32 s58, s58, s59
    buffer_load_dwordx4 v[144:147], v14, s[60:63], s58 offen
    s_add_u32 s58, s58, s59
    buffer_load_dwordx4 v[148:151], v14, s[60:63], s58 offen
    s_add_u32 s58, s58, s59
    buffer_load_dwordx4 v[152:155], v14, s[60:63], s58 offen
    s_add_u32 s58, s58, s59
    buffer_load_dwordx4 v[156:159], v14, s[60:63], s58 offen
    s_add_u32 s58, s58, s59
    buffer_load_dwordx4 v[160:163], v90, s[64:67], s39 offen
    s_add_u32 s39, s39, s38
    buffer_load_dwordx4 v[164:167], v90, s[64:67], s39 offen
    s_add_u32 s39, s39, s38
    buffer_load_dwordx4 v[168:171], v90, s[64:67], s39 offen
    s_add_u32 s39, s39, s38
    buffer_load_dwordx4 v[172:175], v90, s[64:67], s39 offen
    s_add_u32 s39, s39, s38
    buffer_load_dwordx4 v[176:179], v90, s[64:67], s39 offen
    s_add_u32 s39, s39, s38
    buffer_load_dwordx4 v[180:183], v90, s[64:67], s39 offen
    s_add_u32 s39, s39, s38
    buffer_load_dwordx4 v[184:187], v90, s[64:67], s39 offen
    s_add_u32 s39, s39, s38
    buffer_load_dwordx4 v[188:191], v90, s[64:67], s39 offen
    s_add_u32 s39, s39, s38
    s_waitcnt vmcnt(14)
    v_perm_b32 v192, v132, v128, s72
    v_perm_b32 v196, v132, v128, s73
    v_perm_b32 v200, v133, v129, s72
    v_perm_b32 v204, v133, v129, s73
    v_perm_b32 v208, v134, v130, s72
    v_perm_b32 v212, v134, v130, s73
    v_perm_b32 v216, v135, v131, s72
    v_perm_b32 v220, v135, v131, s73
    s_waitcnt vmcnt(12)
    v_perm_b32 v193, v140, v136, s72
    v_perm_b32 v197, v140, v136, s73
    v_perm_b32 v201, v141, v137, s72
    v_perm_b32 v205, v141, v137, s73
    v_perm_b32 v209, v142, v138, s72
    v_perm_b32 v213, v142, v138, s73
    v_perm_b32 v217, v143, v139, s72
    v_perm_b32 v221, v143, v139, s73
    s_waitcnt vmcnt(10)
    v_perm_b32 v194, v148, v144, s72
    v_perm_b32 v198, v148, v144, s73
    v_perm_b32 v202, v149, v145, s72
    v_perm_b32 v206, v149, v145, s73
    v_perm_b32 v210, v150, v146, s72
    v_perm_b32 v214, v150, v146, s73
    v_perm_b32 v218, v151, v147, s72
    v_perm_b32 v222, v151, v147, s73
    s_waitcnt vmcnt(8)
    v_perm_b32 v195, v156, v152, s72
    v_perm_b32 v199, v156, v152, s73
    v_perm_b32 v203, v157, v153, s72
    v_perm_b32 v207, v157, v153, s73
    v_perm_b32 v211, v158, v154, s72
    v_perm_b32 v215, v158, v154, s73
    v_perm_b32 v219, v159, v155, s72
    v_perm_b32 v223, v159, v155, s73
    s_waitcnt vmcnt(6)
    v_perm_b32 v224, v164, v160, s72
    v_perm_b32 v228, v164, v160, s73
    v_perm_b32 v232, v165, v161, s72
    v_perm_b32 v236, v165, v161, s73
    v_perm_b32 v240, v166, v162, s72
    v_perm_b32 v244, v166, v162, s73
    v_perm_b32 v248, v167, v163, s72
    v_perm_b32 v252, v167, v163, s73
    s_waitcnt vmcnt(4)
    v_perm_b32 v225, v172, v168, s72
    v_perm_b32 v229, v172, v168, s73
    v_perm_b32 v233, v173, v169, s72
    v_perm_b32 v237, v173, v169, s73
    v_perm_b32 v241, v174, v170, s72
    v_perm_b32 v245, v174, v170, s73
    v_perm_b32 v249, v175, v171, s72
    v_perm_b32 v253, v175, v171, s73
    s_waitcnt vmcnt(2)
    v_perm_b32 v226, v180, v176, s72
    v_perm_b32 v230, v180, v176, s73
    v_perm_b32 v234, v181, v177, s72
    v_perm_b32 v238, v181, v177, s73
    v_perm_b32 v242, v182, v178, s72
    v_perm_b32 v246, v182, v178, s73
    v_perm_b32 v250, v183, v179, s72
    v_perm_b32 v254, v183, v179, s73
    s_waitcnt vmcnt(0)
    v_perm_b32 v227, v188, v184, s72
    v_perm_b32 v231, v188, v184, s73
    v_perm_b32 v235, v189, v185, s72
    v_perm_b32 v239, v189, v185, s73
    v_perm_b32 v243, v190, v186, s72
    v_perm_b32 v247, v190, v186, s73
    v_perm_b32 v251, v191, v187, s72
    v_perm_b32 v255, v191, v187, s73
    v_mov_b64 v[96:97], 0
    v_mov_b64 v[98:99], 0
    v_mov_b64 v[100:101], 0
    v_mov_b64 v[102:103], 0
    v_mov_b64 v[104:105], 0
    v_mov_b64 v[106:107], 0
    v_mov_b64 v[108:109], 0
    v_mov_b64 v[110:111], 0
    v_mov_b64 v[164:165], 0
    v_mov_b64 v[166:167], 0
    s_mov_b64 exec, s[48:49]
    buffer_load_dwordx4 v[96:99], v8, s[44:47], s20 offen sc1
    buffer_load_dwordx4 v[100:103], v8, s[44:47], s21 offen sc1
    buffer_load_dwordx4 v[104:107], v8, s[44:47], s22 offen sc1
    buffer_load_dwordx4 v[108:111], v8, s[44:47], s23 offen sc1
    s_branch L_pc_578
L_brk2_581:
    s_setpc_b64 s[4:5]
L_brk2_581s:
L_pf_580:
    s_mov_b64 s[4:5], 0
    v_max3_u32 v30, v96, v97, v98
    v_max_u32 v30, v30, v99
    v_cmp_eq_u32 vcc, -1, v30
    s_or_b64 s[4:5], s[4:5], vcc
    s_mov_b64 exec, vcc
    s_cbranch_execz L_sk_582
    buffer_load_dwordx4 v[96:99], v8, s[44:47], s20 offen sc1
L_sk_582:
    s_mov_b64 exec, -1
    v_max3_u32 v30, v100, v101, v102
    v_max_u32 v30, v30, v103
    v_cmp_eq_u32 vcc, -1, v30
    s_or_b64 s[4:5], s[4:5], vcc
    s_mov_b64 exec, vcc
    s_cbranch_execz L_sk_583
    buffer_load_dwordx4 v[100:103], v8, s[44:47], s21 offen sc1
L_sk_583:
    s_mov_b64 exec, -1
    v_max3_u32 v30, v104, v105, v106
    v_max_u32 v30, v30, v107
    v_cmp_eq_u32 vcc, -1, v30
    s_or_b64 s[4:5], s[4:5], vcc
    s_mov_b64 exec, vcc
    s_cbranch_execz L_sk_584
    buffer_load_dwordx4 v[104:107], v8, s[44:47], s22 offen sc1
L_sk_584:
    s_mov_b64 exec, -1
    v_max3_u32 v30, v108, v109, v110
    v_max_u32 v30, v30, v111
    v_cmp_eq_u32 vcc, -1, v30
    s_or_b64 s[4:5], s[4:5], vcc
    s_mov_b64 exec, vcc
    s_cbranch_execz L_sk_585
    buffer_load_dwordx4 v[108:111], v8, s[44:47], s23 offen sc1
L_sk_585:
    s_mov_b64 exec, -1
    s_cmp_eq_u64 s[4:5], 0
    s_cbranch_scc1 L_pd_579
    s_cmp_gt_i32 s74, 0
    s_cbranch_scc1 L_pc_578
    s_waitcnt vmcnt(0)
    s_branch L_pd_579
L_pr_577:
    s_sub_u32 s74, s74, 1
    s_and_b32 s56, s74, 63
    s_cbranch_scc0 L_pf_580
    v_cmp_eq_u32 s[4:5], -1, v99
    v_cmp_eq_u32 s[6:7], -1, v103
    v_cmp_eq_u32 s[8:9], -1, v107
    v_cmp_eq_u32 s[10:11], -1, v111
    s_mov_b64 exec, s[4:5]
    s_cbranch_execz L_sk_586
    buffer_load_dwordx4 v[96:99], v8, s[44:47], s20 offen sc1
L_sk_586:
    s_mov_b64 exec, s[6:7]
    s_cbranch_execz L_sk_587
    buffer_load_dwordx4 v[100:103], v8, s[44:47], s21 offen sc1
L_sk_587:
    s_mov_b64 exec, s[8:9]
    s_cbranch_execz L_sk_588
    buffer_load_dwordx4 v[104:107], v8, s[44:47], s22 offen sc1
L_sk_588:
    s_mov_b64 exec, s[10:11]
    s_cbranch_execz L_sk_589
    buffer_load_dwordx4 v[108:111], v8, s[44:47], s23 offen sc1
L_sk_589:
L_pc_578:
    s_mov_b64 exec, -1
    s_waitcnt vmcnt(0)
    v_pk_add_f32 v[32:33], v[96:97], v[100:101]
    v_pk_add_f32 v[34:35], v[98:99], v[102:103]
    v_pk_add_f32 v[36:37], v[104:105], v[108:109]
    v_pk_add_f32 v[38:39], v[106:107], v[110:111]
    v_pk_add_f32 v[32:33], v[32:33], v[36:37]
    v_pk_add_f32 v[34:35], v[34:35], v[38:39]
    s_nop 1
    v_permlane32_swap_b32 v32, v34
    v_permlane32_swap_b32 v33, v35
    v_pk_add_f32 v[32:33], v[32:33], v[34:35]
    v_cmp_u_f32 vcc, v32, v33
    s_cbranch_vccnz L_pr_577
L_pd_579:
    v_cvt_pk_bf16_f32 v30, v32, v33
    v_lshlrev_b32 v32, 16, v30
    v_and_b32 v33, 0xffff0000, v30
    v_pk_mul_f32 v[32:33], v[32:33], v[16:17]
    v_cvt_pk_bf16_f32 v30, v32, v33
    v_lshlrev_b32 v32, 16, v30
    v_and_b32 v33, 0xffff0000, v30
    v_pk_add_f32 v[36:37], v[32:33], v[22:23]
    v_cvt_pk_bf16_f32 v30, v36, v37
    v_lshlrev_b32 v36, 16, v30
    v_and_b32 v37, 0xffff0000, v30
    v_readfirstlane_b32 s56, v36
    ds_write_b64 v27, v[36:37] offset:28160
    s_nop 0
    v_subrev_f32 v38, s56, v36
    v_subrev_f32 v39, s56, v37
    v_add_f32 v40, v38, v39
    v_mul_f32 v41, v38, v38
    v_fmac_f32 v41, v39, v39
    v_mov_b32 v42, s56
    s_nop 0
    v_permlane32_swap_b32 v40, v41
    v_add_f32 v40, v40, v41
    v_cndmask_b32 v40, 0, v40, s[48:49]
    s_nop 1
    v_add_f32_dpp v40, v40, v40 row_ror:8 row_mask:0xf bank_mask:0xf
    s_nop 1
    v_add_f32_dpp v40, v40, v40 row_ror:4 row_mask:0xf bank_mask:0xf
    s_nop 1
    v_add_f32_dpp v40, v40, v40 row_ror:2 row_mask:0xf bank_mask:0xf
    s_nop 1
    v_add_f32_dpp v40, v40, v40 row_ror:1 row_mask:0xf bank_mask:0xf
    v_mov_b32 v30, v40
    s_nop 1
    v_permlane16_swap_b32 v40, v30
    v_add_f32 v40, v40, v30
    ds_write2_b32 v29, v40, v42 offset0:0 offset1:8
    s_waitcnt lgkmcnt(0)
    s_barrier
    ds_read_b128 v[128:131], v91
    ds_read_b128 v[136:139], v91 offset:32
    ds_read_b128 v[132:135], v91 offset:16
    s_waitcnt lgkmcnt(0)
    v_pk_fma_f32 v[32:33], v[92:93], v[136:137], v[128:129]
    v_pk_fma_f32 v[34:35], v[94:95], v[138:139], v[130:131]
    v_pk_add_f32 v[32:33], v[32:33], v[34:35]
    v_add_f32 v43, v32, v33
    v_mul_f32 v44, 0x3b124925, v43
    v_fmamk_f32 v30, v44, 0xc3e00000, v43
    v_fmac_f32 v44, 0x3b124925, v30
    v_pk_add_f32 v[136:137], v[136:137], v[44:45] op_sel_hi:[1,0] neg_lo:[0,1] neg_hi:[0,1]
    v_pk_add_f32 v[138:139], v[138:139], v[44:45] op_sel_hi:[1,0] neg_lo:[0,1] neg_hi:[0,1]
    v_pk_add_f32 v[128:129], v[128:129], v[128:129]
    v_pk_add_f32 v[130:131], v[130:131], v[130:131]
    v_pk_fma_f32 v[128:129], v[92:93], v[136:137], v[128:129]
    v_pk_fma_f32 v[130:131], v[94:95], v[138:139], v[130:131]
    v_pk_fma_f32 v[132:133], v[128:129], v[136:137], v[132:133]
    v_pk_fma_f32 v[134:135], v[130:131], v[138:139], v[134:135]
    v_pk_add_f32 v[132:133], v[132:133], v[134:135]
    v_add_f32 v46, v132, v133
    v_mul_f32 v46, 0x3b124925, v46
    v_max_f32 v46, 0, v46
    v_cvt_pk_bf16_f32 v30, v44, v46
    v_lshlrev_b32 v44, 16, v30
    v_and_b32 v46, 0xffff0000, v30
    v_add_f32 v46, 0x3727c5ac, v46
    v_cvt_pk_bf16_f32 v46, v46, v46
    v_and_b32 v46, 0xffff0000, v46
    v_sqrt_f32 v46, v46
    v_sub_f32 v38, v36, v44
    v_sub_f32 v39, v37, v44
    v_cvt_pk_bf16_f32 v46, v46, v46
    v_and_b32 v46, 0xffff0000, v46
    v_rcp_f32 v46, v46
    v_cvt_pk_bf16_f32 v30, v38, v39
    v_lshlrev_b32 v38, 16, v30
    v_and_b32 v39, 0xffff0000, v30
    v_mul_f32 v38, v38, v46
    v_mul_f32 v39, v39, v46
    v_cvt_pk_bf16_f32 v30, v38, v39
    v_lshlrev_b32 v38, 16, v30
    v_and_b32 v39, 0xffff0000, v30
    v_pk_mul_f32 v[38:39], v[38:39], v[20:21]
    v_cvt_pk_bf16_f32 v30, v38, v39
    v_lshlrev_b32 v38, 16, v30
    v_and_b32 v39, 0xffff0000, v30
    v_pk_add_f32 v[38:39], v[38:39], v[18:19]
    v_cvt_pk_bf16_f32 v30, v38, v39
    ds_write_b32 v9, v30 offset:25600
    ds_read_b128 v[48:51], v10 offset:25600
    s_waitcnt lgkmcnt(0)
    v_mfma_f32_16x16x32_bf16 v[56:59], v[48:51], v[192:195], 0
    v_mfma_f32_16x16x32_bf16 v[60:63], v[48:51], v[196:199], 0
    v_mfma_f32_16x16x32_bf16 v[64:67], v[48:51], v[200:203], 0
    v_mfma_f32_16x16x32_bf16 v[68:71], v[48:51], v[204:207], 0
    v_mfma_f32_16x16x32_bf16 v[72:75], v[48:51], v[208:211], 0
    v_mfma_f32_16x16x32_bf16 v[76:79], v[48:51], v[212:215], 0
    v_mfma_f32_16x16x32_bf16 v[80:83], v[48:51], v[216:219], 0
    v_mfma_f32_16x16x32_bf16 v[84:87], v[48:51], v[220:223], 0
    ds_read_b32 v47, v28 offset:28160
    s_mov_b32 exec_lo, 0xf0000f
    s_mov_b32 exec_hi, 0xf0000f00
    ds_write2_b32 v12, v56, v60 offset0:0 offset1:1
    ds_write2_b32 v12, v64, v68 offset0:2 offset1:3
    s_nop 0
    ds_write2_b32 v12, v72, v76 offset0:4 offset1:5
    s_nop 0
    ds_write2_b32 v12, v80, v84 offset0:6 offset1:7
    s_mov_b64 exec, -1
    s_waitcnt lgkmcnt(0)
    s_barrier
    ds_read2_b32 v[32:33], v13 offset0:0 offset1:32
    ds_read2_b32 v[34:35], v13 offset0:64 offset1:96
    ds_read2_b32 v[36:37], v13 offset0:128 offset1:160
    ds_read2_b32 v[38:39], v13 offset0:192 offset1:224
    s_waitcnt lgkmcnt(0)
    v_pk_add_f32 v[32:33], v[32:33], v[34:35]
    v_pk_add_f32 v[36:37], v[36:37], v[38:39]
    v_pk_add_f32 v[32:33], v[32:33], v[36:37]
    v_add_f32 v34, v32, v33
    v_add_f32 v32, v32, v33
    s_nop 1
    v_permlane32_swap_b32 v32, v34
    v_add_f32 v32, v32, v34
    v_cvt_pk_bf16_f32 v32, v32, v32
    v_and_b32 v32, 0xffff0000, v32
    v_mul_f32 v33, 0xbfb8aa3b, v32
    v_exp_f32 v33, v33
    s_nop 0
    v_add_f32 v33, 1.0, v33
    v_rcp_f32 v33, v33
    s_nop 0
    v_mul_f32 v32, v32, v33
    v_cvt_pk_bf16_f32 v32, v32, v32
    ds_write_b16 v25, v32 offset:27648
    ds_read_b128 v[48:51], v26 offset:27648
    s_waitcnt lgkmcnt(0)
    v_mfma_f32_16x16x32_bf16 v[56:59], v[48:51], v[224:227], 0
    v_mfma_f32_16x16x32_bf16 v[72:75], v[48:51], v[240:243], 0
    v_mfma_f32_16x16x32_bf16 v[60:63], v[48:51], v[228:231], 0
    v_mfma_f32_16x16x32_bf16 v[76:79], v[48:51], v[244:247], 0
    v_mfma_f32_16x16x32_bf16 v[64:67], v[48:51], v[232:235], 0
    v_mfma_f32_16x16x32_bf16 v[80:83], v[48:51], v[248:251], 0
    v_mfma_f32_16x16x32_bf16 v[68:71], v[48:51], v[236:239], 0
    v_mfma_f32_16x16x32_bf16 v[84:87], v[48:51], v[252:255], 0
    s_nop 1
    v_cndmask_b32 v40, v56, v72, s[50:51]
    v_min_u32 v40, -2, v40
    v_cndmask_b32 v41, v60, v76, s[50:51]
    v_min_u32 v41, -2, v41
    v_cndmask_b32 v42, v64, v80, s[50:51]
    v_min_u32 v42, -2, v42
    v_cndmask_b32 v43, v68, v84, s[50:51]
    v_min_u32 v43, -2, v43
    s_mov_b32 exec_lo, s29
    s_mov_b32 exec_hi, 0
    buffer_store_dwordx4 v[40:43], v15, s[44:47], s36 offen sc1
    s_mov_b64 exec, -1
    s_waitcnt vmcnt(0)
    s_barrier
    s_cmp_lg_u32 s34, 0
    s_cbranch_scc1 L_end2
    buffer_load_dwordx4 v[160:163], v88, s[44:47], s28 offen sc1
    s_mov_b32 exec_hi, 0xffff
    buffer_load_dwordx4 v[164:167], v88, s[44:47], s37 offen sc1
    s_branch L_pc_591
L_pf_593:
    s_mov_b64 s[4:5], 0
    v_max3_u32 v30, v160, v161, v162
    v_max_u32 v30, v30, v163
    v_cmp_eq_u32 vcc, -1, v30
    s_or_b64 s[4:5], s[4:5], vcc
    s_mov_b64 exec, vcc
    s_cbranch_execz L_sk_594
    buffer_load_dwordx4 v[160:163], v88, s[44:47], s28 offen sc1
L_sk_594:
    s_mov_b64 exec, -1
    v_max3_u32 v30, v164, v165, v166
    v_max_u32 v30, v30, v167
    v_cmp_eq_u32 vcc, -1, v30
    s_or_b64 s[4:5], s[4:5], vcc
    s_mov_b64 exec, vcc
    s_cbranch_execz L_sk_595
    buffer_load_dwordx4 v[164:167], v88, s[44:47], s37 offen sc1
L_sk_595:
    s_mov_b64 exec, -1
    s_cmp_eq_u64 s[4:5], 0
    s_cbranch_scc1 L_pd_592
    s_cmp_gt_i32 s74, 0
    s_cbranch_scc1 L_pc_591
    s_waitcnt vmcnt(0)
    s_branch L_pd_592
L_pr_590:
    s_sub_u32 s74, s74, 1
    s_and_b32 s56, s74, 63
    s_cbranch_scc0 L_pf_593
    v_cmp_eq_u32 s[4:5], -1, v163
    v_cmp_eq_u32 s[6:7], -1, v167
    s_mov_b64 exec, s[4:5]
    s_cbranch_execz L_sk_596
    buffer_load_dwordx4 v[160:163], v88, s[44:47], s28 offen sc1
L_sk_596:
    s_mov_b64 exec, s[6:7]
    s_cbranch_execz L_sk_597
    buffer_load_dwordx4 v[164:167], v88, s[44:47], s37 offen sc1
L_sk_597:
L_pc_591:
    s_mov_b64 exec, -1
    s_waitcnt vmcnt(0)
    v_pk_add_f32 v[32:33], v[160:161], v[164:165]
    v_pk_add_f32 v[34:35], v[162:163], v[166:167]
    s_nop 1
    v_permlane32_swap_b32 v32, v34
    v_permlane32_swap_b32 v33, v35
    v_pk_add_f32 v[32:33], v[32:33], v[34:35]
    v_cmp_u_f32 vcc, v32, v33
    s_cbranch_vccnz L_pr_590
L_pd_592:
    v_permlane16_swap_b32 v32, v33
    v_add_f32 v32, v32, v33
    s_nop 1
    v_add_f32_dpp v32, v32, v32 row_ror:8 row_mask:0xf bank_mask:0xf
    s_nop 1
    v_add_f32_dpp v32, v32, v32 row_ror:4 row_mask:0xf bank_mask:0xf
    s_nop 1
    v_add_f32_dpp v32, v32, v32 row_ror:2 row_mask:0xf bank_mask:0xf
    v_cvt_pk_bf16_f32 v32, v32, v32
    v_and_b32 v32, 0xffff0000, v32
    v_mul_f32 v32, v32, v24
    v_cvt_pk_bf16_f32 v32, v32, v32
    v_and_b32 v32, 0xffff0000, v32
    v_add_f32 v32, v32, v47
    v_cvt_pk_bf16_f32 v32, v32, v32
    s_mov_b32 exec_lo, 0x30003
    s_mov_b32 exec_hi, 0x30003
    buffer_store_short v32, v89, s[68:71], 0 offen
L_end2:
L_service_done:
L_end:
    s_endpgm
.section .rodata,"a"
.p2align 6
.amdhsa_kernel adaLN_cond__mha_block_cached__dense_activation_silu__decode_kernel
  .amdhsa_next_free_vgpr 256
  .amdhsa_next_free_sgpr 102
  .amdhsa_accum_offset 256
  .amdhsa_group_segment_fixed_size 0
  .amdhsa_kernarg_size 104
  .amdhsa_user_sgpr_count 2
  .amdhsa_user_sgpr_kernarg_segment_ptr 1
  .amdhsa_system_sgpr_workgroup_id_x 1
.end_amdhsa_kernel
```
